```python
import torch

def _softmax(x, axis=-1):
    return torch.softmax(x, dim=axis)
def _gelu(x):
    return torch.nn.functional.gelu(x, approximate="tanh")
def _silu(x):
    return torch.nn.functional.silu(x)
def _sigmoid(x):
    return torch.sigmoid(x)
def _layernorm(x, axis=-1, eps=1e-5):
    m = x.mean(dim=axis, keepdim=True)
    v = x.var(dim=axis, keepdim=True, unbiased=False)
    return (x - m) / torch.sqrt(v + eps)
def _scatter_add(tgt, idx, src, axis=0):
    return tgt.clone().index_add_(axis, idx, src)
def _segment_sum(src, seg, n):
    out = torch.zeros((n,) + src.shape[1:], dtype=src.dtype)
    return out.index_add_(0, seg, src)
def _pad(x, pw):
    flat = tuple(v for pair in reversed(pw) for v in pair)
    return torch.nn.functional.pad(x, flat)

kernel_name = 'recurrent_scan__ssm_conv_s4__dense_activation_squared_relu__prompt'

def setup_inputs():

    _w = (lambda a: (lambda t: t.to(torch.bfloat16) if t.is_floating_point() else t)(torch.as_tensor(a)))
    def _A_setup():
        B, L, D, N = 1, 2048, 512, 128
        A_re = -(lambda _x: torch.exp(torch.as_tensor(_x)))((lambda *s: torch.randn(*s, dtype=torch.bfloat16) * 3.2)(D, N))
        A_im = torch.pi * (lambda *s: torch.randn(*s, dtype=torch.bfloat16) * 0.05)(D, N)
        B_re = (lambda *s: torch.randn(*s, dtype=torch.bfloat16) * 0.2)(D, N)
        B_im = (lambda *s: torch.randn(*s, dtype=torch.bfloat16) * 0.1)(D, N)
        C_re = (lambda *s: torch.randn(*s, dtype=torch.bfloat16) * 0.2)(D, N)
        C_im = (lambda *s: torch.randn(*s, dtype=torch.bfloat16) * 0.2)(D, N)
        log_dt = (lambda *s: torch.randn(*s, dtype=torch.bfloat16) * 0.05)(D) * 0.5 - 4.0
        Dskip = (lambda *s: torch.randn(*s, dtype=torch.bfloat16) * 0.05)(D)
        return {
            "u": _w((lambda *s: torch.randn(*s, dtype=torch.bfloat16) * 0.05)(B, L, D)),
            "A_re": _w(A_re),
            "A_im": _w(A_im),
            "B_re": _w(B_re),
            "B_im": _w(B_im),
            "C_re": _w(C_re),
            "C_im": _w(C_im),
            "log_dt": _w(log_dt),
            "Dskip": _w(Dskip),
        }
    _A_in = _A_setup()

    def _B_setup():
        B, S, D, F = 1, 2048, 512, 1376
        return {
            "x": _w((lambda *s: torch.randn(*s, dtype=torch.bfloat16) * 0.05)(B, S, D)),
            "w1": _w((lambda *s: torch.randn(*s, dtype=torch.bfloat16) * 0.05)(D, F)),
            "b1": _w((lambda *s: torch.randn(*s, dtype=torch.bfloat16) * 0.4)(F)),
            "w2": _w((lambda *s: torch.randn(*s, dtype=torch.bfloat16) * 0.05)(F, D)),
            "b2": _w((lambda *s: torch.randn(*s, dtype=torch.bfloat16) * 1.6)(D)),
        }
    _B_in = _B_setup()

    return {
        "A_u": _A_in["u"],
        "A_A_re": _A_in["A_re"],
        "A_A_im": _A_in["A_im"],
        "A_B_re": _A_in["B_re"],
        "A_B_im": _A_in["B_im"],
        "A_C_re": _A_in["C_re"],
        "A_C_im": _A_in["C_im"],
        "A_log_dt": _A_in["log_dt"],
        "A_Dskip": _A_in["Dskip"],
        "B_x": _B_in["x"],
        "B_w1": _B_in["w1"],
        "B_b1": _B_in["b1"],
        "B_w2": _B_in["w2"],
        "B_b2": _B_in["b2"],
    }

def reference(A_u, A_A_re, A_A_im, A_B_re, A_B_im, A_C_re, A_C_im, A_log_dt, A_Dskip, B_x, B_w1, B_b1, B_w2, B_b2):
    def _A_ref(u, A_re, A_im, B_re, B_im, C_re, C_im, log_dt, Dskip):
        Bsz, L, D = u.shape
        dt = torch.exp(log_dt)[:, None]
        A = A_re + 1j * A_im
        Bc = B_re + 1j * B_im
        Cc = C_re + 1j * C_im
        logdA = dt * A
        dB = dt * Bc
        l = (lambda x, dt: x.to(dt))(torch.arange(L), A_re.dtype)
        P = torch.exp(logdA[:, :, None] * l[None, None, :])
        K = torch.einsum("dn,dnl,dn->dl", Cc, P, dB).real
        L2 = 2 * L
        Kp = _pad(K, ((0, 0), (0, L)))
        up = (lambda x, *d: x.permute(*d))(u, 0, 2, 1)
        up = _pad(up, ((0, 0), (0, 0), (0, L)))
        Kf = (lambda x, axes=(-2,-1): torch.fft.rfft2(x.float(), dim=axes))(Kp[:, None, :], axes=(-2, -1))
        Uf = (lambda x, axes=(-2,-1): torch.fft.rfft2(x.float(), dim=axes))(up[:, :, None, :], axes=(-2, -1))
        Yf = Uf * Kf[None, :, :, :]
        y = (lambda x, s, axes=(-2,-1): torch.fft.irfft2(x, s=s, dim=axes).to(torch.bfloat16))(Yf, (1, L2), axes=(-2, -1))[:, :, 0, :L]
        y = (lambda x, *d: x.permute(*d))(y, 0, 2, 1) + u * Dskip[None, None, :]
        return y

    def _B_ref(x, w1, b1, w2, b2):
        h = torch.einsum("bsd,df->bsf", x, w1) + b1
        zero = torch.zeros_like(h)
        r = torch.where(h > zero, h, zero)
        h = r * r
        out = torch.einsum("bsf,fd->bsd", h, w2) + b2
        return out

    x = A_u
    xn = _layernorm(x, axis=-1)
    s = _A_ref(xn, A_A_re, A_A_im, A_B_re, A_B_im, A_C_re, A_C_im, A_log_dt, A_Dskip)
    g = _silu(_B_ref(xn, B_w1, B_b1, B_w2, B_b2))
    return x + s * g
```

```asm
; @launch grid=(512,1,1) block=(256,1,1) lds=81920
.amdgcn_target "amdgcn-amd-amdhsa--gfx950"
.text
.globl recurrent_scan__ssm_conv_s4__dense_activation_squared_relu__prompt_kernel
.p2align 8
.type recurrent_scan__ssm_conv_s4__dense_activation_squared_relu__prompt_kernel,@function
recurrent_scan__ssm_conv_s4__dense_activation_squared_relu__prompt_kernel:

    s_cmp_ge_u32 s2, 256
    s_cbranch_scc1 L_second
L_K:
    s_setprio 2
    s_memrealtime s[76:77]
    s_load_dwordx16 s[4:19], s[0:1], 0
    s_load_dwordx2 s[20:21], s[0:1], 64
    s_load_dwordx4 s[24:27], s[0:1], 120
    s_load_dwordx2 s[22:23], s[0:1], 96
    s_load_dwordx2 s[68:69], s[0:1], 80
    s_getpc_b64 s[74:75]
    s_bfe_u32 s72, s2, 0x50003
    s_mul_i32 s72, s72, 512
    v_lshlrev_b32 v3, 7, v0
    v_add_u32_e64 v3, s72, v3
    v_min_u32 v3, 14408, v3
    v_cmp_gt_u32_e64 vcc, 4, v0
    s_nop 0
    s_and_saveexec_b64 s[72:73], vcc
    global_load_dword v3, v3, s[74:75]
    s_mov_b64 exec, s[72:73]
    s_and_b32 s3, s2, 255
    v_and_b32 v1, 63, v0
    v_lshrrev_b32 v2, 6, v0
    s_nop 0
    v_readfirstlane_b32 s28, v2
    s_and_b32 s29, s3, 7
    s_lshl_b32 s29, s29, 5
    s_lshr_b32 s30, s3, 3
    s_add_u32 s29, s29, s30
    s_lshr_b32 s30, s28, 1
    s_and_b32 s31, s28, 1
    s_lshl_b32 s32, s29, 1
    s_add_u32 s32, s32, s30
    s_lshl_b32 s33, s31, 7
    s_lshl_b32 s34, s32, 8
    s_add_u32 s33, s33, s34
    v_and_b32_e64 v2, 7, v1
    v_lshl_add_u32 v2, v2, 4, s33
    s_lshl_b32 s34, s3, 3
    s_lshl_b32 s35, s28, 1
    s_add_u32 s34, s34, s35
    s_lshl_b32 s34, s34, 10
    v_lshrrev_b32 v5, 5, v1
    v_and_b32 v6, 31, v1
    v_lshlrev_b32_e64 v4, 10, v5
    v_lshl_add_u32 v4, v6, 4, v4
    v_add_u32 v4, s34, v4
    v_mov_b32 v122, 0
    v_lshlrev_b32_e64 v7, 4, v1
    s_lshl_b32 s33, s29, 2
    s_lshl_b32 s57, s3, 12
    s_lshl_b32 s58, s28, 10
    s_add_u32 s57, s57, s58
    s_add_u32 s58, s57, 1048576
    s_waitcnt lgkmcnt(0)
    s_mov_b64 exec, 0xff
    v_mov_b32 v136, s6
    v_mov_b32 v137, s7
    s_lshl_b64 exec, exec, 8
    v_mov_b32 v136, s8
    v_mov_b32 v137, s9
    s_lshl_b64 exec, exec, 8
    v_mov_b32 v136, s10
    v_mov_b32 v137, s11
    s_lshl_b64 exec, exec, 8
    v_mov_b32 v136, s12
    v_mov_b32 v137, s13
    s_lshl_b64 exec, exec, 8
    v_mov_b32 v136, s14
    v_mov_b32 v137, s15
    s_lshl_b64 exec, exec, 8
    v_mov_b32 v136, s16
    v_mov_b32_e64 v137, s17
    s_mov_b32 exec_lo, -1
    s_mov_b32 exec_hi, 0xffff
    v_add_co_u32 v136, vcc, v136, v2
    s_nop 1
    v_addc_co_u32_e64 v137, vcc, 0, v137, vcc
    global_load_dwordx4 v[140:143], v[136:137], off
    s_mov_b64 exec, -1
    s_load_dword s36, s[20:21], s33
    s_load_dword s52, s[18:19], s33
    s_or_b32 s76, s76, 1
    s_or_b32 s61, s3, s28
    s_cmp_lg_u32 s61, 0
    s_cbranch_scc1 L_K_notag
    v_mov_b32_e64 v123, s76
    s_mov_b64 exec, 1
    global_store_dword v122, v123, s[24:25] sc1
    s_mov_b64 exec, -1
L_K_notag:
    global_load_dwordx4 v[160:163], v4, s[4:5]
    global_load_dwordx4 v[164:167], v4, s[4:5] offset:512
    s_mov_b32 s44, s26
    s_mov_b32 s45, s27
    s_mov_b32 s46, 0xf00000
    s_mov_b32 s47, 0x20000
    s_mov_b32 s64, s68
    s_mov_b32 s65, s69
    s_mov_b32 s66, 0x158000
    s_mov_b32 s67, 0x20000
    buffer_load_dwordx4 v[60:63], v7, s[64:67], s57 offen
    buffer_load_dwordx4 v[60:63], v7, s[64:67], s58 offen
    s_mov_b32 s56, 0x3f803f80
    s_mov_b32 s59, 0xffff0000
    v_and_b32 v56, 15, v1
    v_cvt_f32_u32_e64 v56, v56
    s_mul_i32 s60, s28, 2176
    s_add_u32 s60, s60, 58368
    v_mul_u32_u24 v182, 1088, v5
    v_lshl_add_u32 v182, v6, 4, v182
    v_add_u32 v182, s60, v182
    v_mov_b32 v168, 0
    v_mov_b32 v169, 0
    s_lshl_b32 s54, s28, 8
    s_add_u32 s54, s54, 58368
    v_bfe_u32 v183, v1, 2, 2
    v_mul_u32_u24 v183, 1088, v183
    v_lshrrev_b32_e64 v18, 4, v1
    v_lshl_add_u32 v183, v18, 5, v183
    v_and_b32_e64 v18, 3, v1
    v_lshl_add_u32 v183, v18, 3, v183
    v_add_u32 v183, s54, v183
    s_lshl_b32 s54, s3, 13
    s_lshl_b32 s55, s28, 11
    s_add_u32 s54, s54, s55
    s_add_u32 s55, s54, 0x200000
    s_lshl_b32 s53, s28, 10
    s_add_u32 s53, s53, 54272
    v_add_u32 v138, s53, v7
    v_lshl_add_u32 v139, v1, 1, s53
    s_mul_i32 s37, s30, 5888
    s_add_u32 s37, s37, 42528
    s_mov_b32 s38, -17024
    s_movk_i32 s39, 127
    s_lshl_b32 s40, s31, 10
    v_lshl_add_u32 v20, v1, 3, s40
    v_sub_u32 v200, 2047, v20
    v_sub_u32 v201, 2046, v20
    v_sub_u32 v202, 2045, v20
    v_sub_u32 v203, 2044, v20
    v_sub_u32 v204, 2043, v20
    v_sub_u32 v205, 2042, v20
    v_sub_u32 v206, 2041, v20
    v_sub_u32 v207, 2040, v20
    v_sub_u32 v208, 2039, v20
    v_sub_u32 v209, 2038, v20
    v_sub_u32 v210, 2037, v20
    v_cvt_f32_u32 v24, v200
    v_cvt_f32_u32 v25, v201
    v_cvt_f32_u32 v26, v202
    v_cvt_f32_u32 v27, v203
    v_cvt_f32_u32 v28, v204
    v_cvt_f32_u32 v29, v205
    v_cvt_f32_u32 v30, v206
    v_cvt_f32_u32 v31, v207
    v_cvt_f32_u32 v32, v208
    v_cvt_f32_u32 v33, v209
    v_cvt_f32_u32_e64 v34, v210
    v_cvt_pk_bf16_f32 v36, v24, v25
    v_cvt_pk_bf16_f32 v37, v26, v27
    v_cvt_pk_bf16_f32 v38, v28, v29
    v_cvt_pk_bf16_f32 v39, v30, v31
    v_cvt_pk_bf16_f32 v40, v32, v33
    v_cvt_pk_bf16_f32 v41, v34, v34
    v_mad_u32_u16 v24, v36, 1, s38
    v_mad_u32_u16 v25, v36, 1, s38 op_sel:[1,0,0,0]
    v_mad_u32_u16 v26, v37, 1, s38
    v_mad_u32_u16 v27, v37, 1, s38 op_sel:[1,0,0,0]
    v_mad_u32_u16 v28, v38, 1, s38
    v_mad_u32_u16 v29, v38, 1, s38 op_sel:[1,0,0,0]
    v_mad_u32_u16 v30, v39, 1, s38
    v_mad_u32_u16 v31, v39, 1, s38 op_sel:[1,0,0,0]
    v_mad_u32_u16 v32, v40, 1, s38
    v_mad_u32_u16 v33, v40, 1, s38 op_sel:[1,0,0,0]
    v_mad_u32_u16 v34, v41, 1, s38
    v_med3_i32 v24, v24, v200, s39
    v_med3_i32 v25, v25, v201, s39
    v_med3_i32 v26, v26, v202, s39
    v_med3_i32 v27, v27, v203, s39
    v_med3_i32 v28, v28, v204, s39
    v_med3_i32 v29, v29, v205, s39
    v_med3_i32 v30, v30, v206, s39
    v_med3_i32 v31, v31, v207, s39
    v_med3_i32 v32, v32, v208, s39
    v_med3_i32 v33, v33, v209, s39
    v_med3_i32 v34, v34, v210, s39
    v_ashrrev_i32 v200, 3, v24
    v_ashrrev_i32 v201, 3, v25
    v_ashrrev_i32 v202, 3, v26
    v_ashrrev_i32 v203, 3, v27
    v_ashrrev_i32 v204, 3, v28
    v_ashrrev_i32 v205, 3, v29
    v_ashrrev_i32 v206, 3, v30
    v_ashrrev_i32 v207, 3, v31
    v_ashrrev_i32 v208, 3, v32
    v_ashrrev_i32 v209, 3, v33
    v_ashrrev_i32 v210, 3, v34
    v_add_u32 v24, v24, v200
    v_add_u32 v25, v25, v201
    v_add_u32 v26, v26, v202
    v_add_u32 v27, v27, v203
    v_add_u32 v28, v28, v204
    v_add_u32 v29, v29, v205
    v_add_u32 v30, v30, v206
    v_add_u32 v31, v31, v207
    v_add_u32 v32, v32, v208
    v_add_u32 v33, v33, v209
    v_add_u32 v34, v34, v210
    v_lshl_add_u32 v200, v24, 3, s37
    v_lshl_add_u32 v201, v25, 3, s37
    v_lshl_add_u32 v202, v26, 3, s37
    v_lshl_add_u32 v203, v27, 3, s37
    v_lshl_add_u32 v204, v28, 3, s37
    v_lshl_add_u32 v205, v29, 3, s37
    v_lshl_add_u32 v206, v30, 3, s37
    v_lshl_add_u32 v207, v31, 3, s37
    v_lshl_add_u32 v208, v32, 3, s37
    v_lshl_add_u32 v209, v33, 3, s37
    v_lshl_add_u32 v210, v34, 3, s37
    v_sub_u32 v211, 1535, v20
    v_sub_u32 v212, 1534, v20
    v_sub_u32 v213, 1533, v20
    v_sub_u32 v214, 1532, v20
    v_sub_u32 v215, 1531, v20
    v_sub_u32 v216, 1530, v20
    v_sub_u32 v217, 1529, v20
    v_sub_u32 v218, 1528, v20
    v_sub_u32 v219, 1527, v20
    v_sub_u32 v220, 1526, v20
    v_sub_u32 v221, 1525, v20
    v_cvt_f32_u32 v24, v211
    v_cvt_f32_u32 v25, v212
    v_cvt_f32_u32 v26, v213
    v_cvt_f32_u32 v27, v214
    v_cvt_f32_u32 v28, v215
    v_cvt_f32_u32 v29, v216
    v_cvt_f32_u32 v30, v217
    v_cvt_f32_u32 v31, v218
    v_max_i32 v32, 0, v219
    v_cvt_f32_u32 v32, v32
    v_max_i32 v33, 0, v220
    v_cvt_f32_u32 v33, v33
    v_max_i32 v34, 0, v221
    v_cvt_f32_u32 v34, v34
    v_cvt_pk_bf16_f32 v36, v24, v25
    v_cvt_pk_bf16_f32 v37, v26, v27
    v_cvt_pk_bf16_f32 v38, v28, v29
    v_cvt_pk_bf16_f32 v39, v30, v31
    v_cvt_pk_bf16_f32 v40, v32, v33
    v_cvt_pk_bf16_f32 v41, v34, v34
    v_mad_u32_u16 v24, v36, 1, s38
    v_mad_u32_u16 v25, v36, 1, s38 op_sel:[1,0,0,0]
    v_mad_u32_u16 v26, v37, 1, s38
    v_mad_u32_u16 v27, v37, 1, s38 op_sel:[1,0,0,0]
    v_mad_u32_u16 v28, v38, 1, s38
    v_mad_u32_u16 v29, v38, 1, s38 op_sel:[1,0,0,0]
    v_mad_u32_u16 v30, v39, 1, s38
    v_mad_u32_u16 v31, v39, 1, s38 op_sel:[1,0,0,0]
    v_mad_u32_u16 v32, v40, 1, s38
    v_mad_u32_u16 v33, v40, 1, s38 op_sel:[1,0,0,0]
    v_mad_u32_u16 v34, v41, 1, s38
    v_med3_i32 v24, v24, v211, s39
    v_med3_i32 v25, v25, v212, s39
    v_med3_i32 v26, v26, v213, s39
    v_med3_i32 v27, v27, v214, s39
    v_med3_i32 v28, v28, v215, s39
    v_med3_i32 v29, v29, v216, s39
    v_med3_i32 v30, v30, v217, s39
    v_med3_i32 v31, v31, v218, s39
    v_med3_i32 v32, v32, v219, s39
    v_med3_i32 v33, v33, v220, s39
    v_med3_i32 v34, v34, v221, s39
    v_ashrrev_i32 v211, 3, v24
    v_ashrrev_i32 v212, 3, v25
    v_ashrrev_i32 v213, 3, v26
    v_ashrrev_i32 v214, 3, v27
    v_ashrrev_i32 v215, 3, v28
    v_ashrrev_i32 v216, 3, v29
    v_ashrrev_i32 v217, 3, v30
    v_ashrrev_i32 v218, 3, v31
    v_ashrrev_i32 v219, 3, v32
    v_ashrrev_i32 v220, 3, v33
    v_ashrrev_i32 v221, 3, v34
    v_add_u32 v24, v24, v211
    v_add_u32 v25, v25, v212
    v_add_u32 v26, v26, v213
    v_add_u32 v27, v27, v214
    v_add_u32 v28, v28, v215
    v_add_u32 v29, v29, v216
    v_add_u32 v30, v30, v217
    v_add_u32 v31, v31, v218
    v_add_u32 v32, v32, v219
    v_add_u32 v33, v33, v220
    v_add_u32 v34, v34, v221
    v_lshl_add_u32 v211, v24, 3, s37
    v_lshl_add_u32 v212, v25, 3, s37
    v_lshl_add_u32 v213, v26, 3, s37
    v_lshl_add_u32 v214, v27, 3, s37
    v_lshl_add_u32 v215, v28, 3, s37
    v_lshl_add_u32 v216, v29, 3, s37
    v_lshl_add_u32 v217, v30, 3, s37
    v_lshl_add_u32 v218, v31, 3, s37
    v_lshl_add_u32 v219, v32, 3, s37
    v_lshl_add_u32 v220, v33, 3, s37
    v_lshl_add_u32 v221, v34, 3, s37
    v_mov_b32 v24, 0
    v_mov_b32 v25, 0
    v_mov_b32 v26, 0
    v_mov_b32 v27, 0
    s_mul_i32 s43, s30, 4608
    s_add_u32 s43, s43, 33280
    v_lshl_add_u32 v10, v1, 3, s43
    ds_write_b64 v10, v[24:25]
    s_mul_i32 s48, s30, 16640
    v_and_b32 v121, 1, v1
    v_lshrrev_b32 v10, 1, v1
    v_mul_u32_u24 v11, 4160, v10
    v_lshl_add_u32 v11, v121, 4, v11
    v_add_u32 v11, s48, v11
    s_sub_u32 s50, s37, 32
    v_lshl_add_u32 v12, v121, 4, s50
    s_mov_b64 exec, 0xff
    ds_write_b128 v11, v[24:27] offset:4096
    ds_write_b128 v12, v[24:27]
    s_mov_b64 exec, -1
    v_lshlrev_b32 v32, 13, v10
    v_lshl_add_u32 v32, v121, 4, v32
    v_mul_u32_u24 v33, 4608, v121
    v_lshl_add_u32 v33, v10, 4, v33
    s_lshl_b32 s49, s28, 10
    s_add_u32 s49, s49, 33792
    v_add_u32_e64 v33, s49, v33
    s_lshl_b32 s71, s28, 13
    v_lshl_add_u32 v120, v1, 7, s71
    s_mov_b32 s41, 0xc00000
    s_lshl_b32 s42, s31, 2
    s_add_u32 s42, s42, s37
    v_and_b32 v8, 15, v1
    v_lshrrev_b32 v14, 4, v1
    v_mul_u32_u24 v34, 144, v8
    v_lshl_add_u32 v34, v14, 5, v34
    v_lshl_add_u32 v34, v5, 3, v34
    v_add_u32_e64 v34, s42, v34
    v_add_u32 v35, 1152, v34
    v_add_u32 v36, 2304, v34
    v_add_u32 v37, 3456, v34
    v_mov_b32 v39, s42
    s_lshl_b32 s49, s31, 11
    s_add_u32 s50, s49, s48
    v_add_u32 v40, s50, v7
    v_and_b32_e64 v41, 3, v1
    v_mul_u32_u24 v41, 4160, v41
    v_bfe_u32 v13, v1, 2, 2
    v_lshlrev_b32_e64 v13, 3, v13
    v_lshl_add_u32 v13, v14, 4, v13
    v_sub_u32_e64 v41, v41, v13
    s_add_u32 s50, s48, 72
    v_add_u32 v41, s50, v41
    v_lshlrev_b32 v42, 5, v8
    v_lshlrev_b32 v15, 4, v14
    v_sub_u32 v42, v42, v15
    s_add_u32 s50, s43, 80
    v_add_u32 v42, s50, v42
    v_lshlrev_b32 v43, 5, v8
    v_lshl_add_u32 v43, v14, 3, v43
    s_add_u32 s50, s43, s49
    s_add_u32 s50, s50, 512
    v_add_u32_e64 v44, s50, v43
    s_waitcnt vmcnt(4) lgkmcnt(0)
    global_load_dword v123, v122, s[24:25] sc1
    ds_write_b128 v138, v[140:143]
    s_lshl_b32 s53, s30, 4
    s_lshr_b32 s52, s52, s53
    v_mov_b32 v54, s52
    s_waitcnt lgkmcnt(0)
    ds_read_u16 v48, v139 offset:0
    ds_read_u16 v49, v139 offset:128
    ds_read_u16 v50, v139 offset:256
    ds_read_u16 v51, v139 offset:384
    ds_read_u16 v52, v139 offset:512
    ds_read_u16 v53, v139 offset:640
    s_waitcnt lgkmcnt(0)
    v_lshlrev_b32 v48, 16, v48
    v_lshlrev_b32 v49, 16, v49
    v_lshlrev_b32 v50, 16, v50
    v_lshlrev_b32 v51, 16, v51
    v_lshlrev_b32 v52, 16, v52
    v_lshlrev_b32 v53, 16, v53
    v_lshlrev_b32 v54, 16, v54
    s_mov_b32 s62, 0x3fb8aa3b
    s_mov_b32 s63, 0x32a57060
    v_mul_f32_e64 v8, s62, v54
    v_fma_f32 v9, v54, s62, -v8
    v_fma_f32 v9, v54, s63, v9
    v_exp_f32_e64 v8, v8
    v_mul_f32 v9, 0x3f317218, v9
    v_fma_f32 v8, v8, v9, v8
    v_cvt_pk_bf16_f32 v8, 0, v8
    v_mul_f32 v48, v8, v48
    v_mul_f32 v49, v8, v49
    v_mul_f32 v50, v8, v50
    v_mul_f32 v51, v8, v51
    v_mul_f32 v48, s62, v48
    v_mul_f32 v49, 0x3e22f983, v49
    v_rndne_f32 v9, v49
    v_sub_f32 v49, v49, v9
    v_mul_f32 v9, v53, v51
    v_mul_f32 v10, v53, v50
    v_fma_f32 v50, v52, v50, -v9
    v_fma_f32 v51, v52, v51, v10
    v_mul_f32_dpp v8, v48, v56 row_newbcast:0 row_mask:0xf bank_mask:0xf
    v_mul_f32_dpp v9, v48, v56 row_newbcast:1 row_mask:0xf bank_mask:0xf
    v_mul_f32_dpp v12, v49, v56 row_newbcast:0 row_mask:0xf bank_mask:0xf
    v_mul_f32_dpp v13, v49, v56 row_newbcast:1 row_mask:0xf bank_mask:0xf
    v_exp_f32 v8, v8
    v_exp_f32 v9, v9
    v_cos_f32 v10, v12
    v_cos_f32 v11, v13
    v_sin_f32 v12, v12
    v_sin_f32 v13, v13
    v_pk_mul_f32 v[16:17], v[8:9], v[10:11]
    v_pk_mul_f32 v[18:19], v[8:9], v[12:13]
    v_cvt_pk_bf16_f32 v64, v16, v17
    v_cvt_pk_bf16_f32 v65, -v18, -v19
    v_pk_mul_f32 v[14:15], v[18:19], v[18:19]
    v_pk_mul_f32 v[22:23], v[16:17], v[18:19]
    v_pk_fma_f32 v[20:21], v[16:17], v[16:17], v[14:15] neg_lo:[0,0,1] neg_hi:[0,0,1]
    v_pk_add_f32 v[22:23], v[22:23], v[22:23]
    v_cvt_pk_bf16_f32 v68, v20, v21
    v_cvt_pk_bf16_f32 v69, -v22, -v23
    v_pk_mul_f32 v[14:15], v[22:23], v[22:23]
    v_pk_mul_f32 v[18:19], v[20:21], v[22:23]
    v_pk_fma_f32 v[16:17], v[20:21], v[20:21], v[14:15] neg_lo:[0,0,1] neg_hi:[0,0,1]
    v_pk_add_f32 v[18:19], v[18:19], v[18:19]
    v_cvt_pk_bf16_f32 v72, v16, v17
    v_cvt_pk_bf16_f32 v73, -v18, -v19
    v_pk_mul_f32 v[14:15], v[18:19], v[18:19]
    v_pk_mul_f32 v[22:23], v[16:17], v[18:19]
    v_pk_fma_f32 v[20:21], v[16:17], v[16:17], v[14:15] neg_lo:[0,0,1] neg_hi:[0,0,1]
    v_pk_add_f32 v[22:23], v[22:23], v[22:23]
    v_cvt_pk_bf16_f32 v76, v20, v21
    v_cvt_pk_bf16_f32 v77, -v22, -v23
    v_pk_mul_f32 v[14:15], v[22:23], v[22:23]
    v_pk_mul_f32 v[18:19], v[20:21], v[22:23]
    v_pk_fma_f32 v[16:17], v[20:21], v[20:21], v[14:15] neg_lo:[0,0,1] neg_hi:[0,0,1]
    v_pk_add_f32 v[18:19], v[18:19], v[18:19]
    s_nop 0
    v_mul_f32_dpp v24, v50, v16 row_newbcast:0 row_mask:0xf bank_mask:0xf
    v_mul_f32_dpp v26, v50, v18 row_newbcast:0 row_mask:0xf bank_mask:0xf
    s_nop 0
    v_fmac_f32_dpp v24, -v51, v18 row_newbcast:0 row_mask:0xf bank_mask:0xf
    v_fmac_f32_dpp v26, v51, v16 row_newbcast:0 row_mask:0xf bank_mask:0xf
    v_mul_f32_dpp v25, v50, v17 row_newbcast:1 row_mask:0xf bank_mask:0xf
    v_mul_f32_dpp v27, v50, v19 row_newbcast:1 row_mask:0xf bank_mask:0xf
    s_nop 0
    s_nop 0
    v_fmac_f32_dpp v25, -v51, v19 row_newbcast:1 row_mask:0xf bank_mask:0xf
    v_fmac_f32_dpp v27, v51, v17 row_newbcast:1 row_mask:0xf bank_mask:0xf
    v_cvt_pk_bf16_f32 v84, v24, v25
    v_cvt_pk_bf16_f32 v85, v26, v27
    v_pk_mul_f32 v[14:15], v[26:27], v[18:19]
    v_pk_mul_f32 v[30:31], v[26:27], v[16:17]
    v_pk_fma_f32 v[28:29], v[24:25], v[16:17], v[14:15] neg_lo:[0,0,1] neg_hi:[0,0,1]
    v_pk_fma_f32 v[30:31], v[24:25], v[18:19], v[30:31]
    v_cvt_pk_bf16_f32 v88, v28, v29
    v_cvt_pk_bf16_f32 v89, v30, v31
    v_pk_mul_f32 v[14:15], v[18:19], v[18:19]
    v_pk_mul_f32 v[22:23], v[16:17], v[18:19]
    v_pk_fma_f32 v[20:21], v[16:17], v[16:17], v[14:15] neg_lo:[0,0,1] neg_hi:[0,0,1]
    v_pk_add_f32 v[22:23], v[22:23], v[22:23]
    v_pk_mul_f32 v[14:15], v[30:31], v[22:23]
    v_pk_mul_f32 v[26:27], v[30:31], v[20:21]
    v_pk_fma_f32 v[24:25], v[28:29], v[20:21], v[14:15] neg_lo:[0,0,1] neg_hi:[0,0,1]
    v_pk_fma_f32 v[26:27], v[28:29], v[22:23], v[26:27]
    v_cvt_pk_bf16_f32 v92, v24, v25
    v_cvt_pk_bf16_f32 v93, v26, v27
    v_pk_mul_f32 v[14:15], v[22:23], v[22:23]
    v_pk_mul_f32 v[18:19], v[20:21], v[22:23]
    v_pk_fma_f32 v[16:17], v[20:21], v[20:21], v[14:15] neg_lo:[0,0,1] neg_hi:[0,0,1]
    v_pk_add_f32 v[18:19], v[18:19], v[18:19]
    v_cvt_pk_bf16_f32 v80, v16, v17
    v_cvt_pk_bf16_f32 v81, -v18, -v19
    v_pk_mul_f32 v[14:15], v[26:27], v[18:19]
    v_pk_mul_f32 v[30:31], v[26:27], v[16:17]
    v_pk_fma_f32 v[28:29], v[24:25], v[16:17], v[14:15] neg_lo:[0,0,1] neg_hi:[0,0,1]
    v_pk_fma_f32 v[30:31], v[24:25], v[18:19], v[30:31]
    v_cvt_pk_bf16_f32 v96, v28, v29
    v_cvt_pk_bf16_f32 v97, v30, v31
    v_mul_f32_dpp v8, v48, v56 row_newbcast:2 row_mask:0xf bank_mask:0xf
    v_mul_f32_dpp v9, v48, v56 row_newbcast:3 row_mask:0xf bank_mask:0xf
    v_mul_f32_dpp v12, v49, v56 row_newbcast:2 row_mask:0xf bank_mask:0xf
    v_mul_f32_dpp v13, v49, v56 row_newbcast:3 row_mask:0xf bank_mask:0xf
    v_exp_f32 v8, v8
    v_exp_f32 v9, v9
    v_cos_f32 v10, v12
    v_cos_f32 v11, v13
    v_sin_f32 v12, v12
    v_sin_f32 v13, v13
    v_pk_mul_f32 v[16:17], v[8:9], v[10:11]
    v_pk_mul_f32 v[18:19], v[8:9], v[12:13]
    v_cvt_pk_bf16_f32 v66, v16, v17
    v_cvt_pk_bf16_f32 v67, -v18, -v19
    v_pk_mul_f32 v[14:15], v[18:19], v[18:19]
    v_pk_mul_f32 v[22:23], v[16:17], v[18:19]
    v_pk_fma_f32 v[20:21], v[16:17], v[16:17], v[14:15] neg_lo:[0,0,1] neg_hi:[0,0,1]
    v_pk_add_f32 v[22:23], v[22:23], v[22:23]
    v_cvt_pk_bf16_f32 v70, v20, v21
    v_cvt_pk_bf16_f32 v71, -v22, -v23
    v_pk_mul_f32 v[14:15], v[22:23], v[22:23]
    v_pk_mul_f32 v[18:19], v[20:21], v[22:23]
    v_pk_fma_f32 v[16:17], v[20:21], v[20:21], v[14:15] neg_lo:[0,0,1] neg_hi:[0,0,1]
    v_pk_add_f32 v[18:19], v[18:19], v[18:19]
    v_cvt_pk_bf16_f32 v74, v16, v17
    v_cvt_pk_bf16_f32 v75, -v18, -v19
    v_pk_mul_f32 v[14:15], v[18:19], v[18:19]
    v_pk_mul_f32 v[22:23], v[16:17], v[18:19]
    v_pk_fma_f32 v[20:21], v[16:17], v[16:17], v[14:15] neg_lo:[0,0,1] neg_hi:[0,0,1]
    v_pk_add_f32 v[22:23], v[22:23], v[22:23]
    v_cvt_pk_bf16_f32 v78, v20, v21
    v_cvt_pk_bf16_f32 v79, -v22, -v23
    v_pk_mul_f32 v[14:15], v[22:23], v[22:23]
    v_pk_mul_f32 v[18:19], v[20:21], v[22:23]
    v_pk_fma_f32 v[16:17], v[20:21], v[20:21], v[14:15] neg_lo:[0,0,1] neg_hi:[0,0,1]
    v_pk_add_f32 v[18:19], v[18:19], v[18:19]
    s_nop 0
    v_mul_f32_dpp v24, v50, v16 row_newbcast:2 row_mask:0xf bank_mask:0xf
    v_mul_f32_dpp v26, v50, v18 row_newbcast:2 row_mask:0xf bank_mask:0xf
    s_nop 0
    v_fmac_f32_dpp v24, -v51, v18 row_newbcast:2 row_mask:0xf bank_mask:0xf
    v_fmac_f32_dpp v26, v51, v16 row_newbcast:2 row_mask:0xf bank_mask:0xf
    v_mul_f32_dpp v25, v50, v17 row_newbcast:3 row_mask:0xf bank_mask:0xf
    v_mul_f32_dpp v27, v50, v19 row_newbcast:3 row_mask:0xf bank_mask:0xf
    s_nop 0
    s_nop 0
    v_fmac_f32_dpp v25, -v51, v19 row_newbcast:3 row_mask:0xf bank_mask:0xf
    v_fmac_f32_dpp v27, v51, v17 row_newbcast:3 row_mask:0xf bank_mask:0xf
    v_cvt_pk_bf16_f32 v86, v24, v25
    v_cvt_pk_bf16_f32 v87, v26, v27
    v_pk_mul_f32 v[14:15], v[26:27], v[18:19]
    v_pk_mul_f32 v[30:31], v[26:27], v[16:17]
    v_pk_fma_f32 v[28:29], v[24:25], v[16:17], v[14:15] neg_lo:[0,0,1] neg_hi:[0,0,1]
    v_pk_fma_f32 v[30:31], v[24:25], v[18:19], v[30:31]
    v_cvt_pk_bf16_f32 v90, v28, v29
    v_cvt_pk_bf16_f32 v91, v30, v31
    v_pk_mul_f32 v[14:15], v[18:19], v[18:19]
    v_pk_mul_f32 v[22:23], v[16:17], v[18:19]
    v_pk_fma_f32 v[20:21], v[16:17], v[16:17], v[14:15] neg_lo:[0,0,1] neg_hi:[0,0,1]
    v_pk_add_f32 v[22:23], v[22:23], v[22:23]
    v_pk_mul_f32 v[14:15], v[30:31], v[22:23]
    v_pk_mul_f32 v[26:27], v[30:31], v[20:21]
    v_pk_fma_f32 v[24:25], v[28:29], v[20:21], v[14:15] neg_lo:[0,0,1] neg_hi:[0,0,1]
    v_pk_fma_f32 v[26:27], v[28:29], v[22:23], v[26:27]
    v_cvt_pk_bf16_f32 v94, v24, v25
    v_cvt_pk_bf16_f32 v95, v26, v27
    v_pk_mul_f32 v[14:15], v[22:23], v[22:23]
    v_pk_mul_f32 v[18:19], v[20:21], v[22:23]
    v_pk_fma_f32 v[16:17], v[20:21], v[20:21], v[14:15] neg_lo:[0,0,1] neg_hi:[0,0,1]
    v_pk_add_f32 v[18:19], v[18:19], v[18:19]
    v_cvt_pk_bf16_f32 v82, v16, v17
    v_cvt_pk_bf16_f32 v83, -v18, -v19
    v_pk_mul_f32 v[14:15], v[26:27], v[18:19]
    v_pk_mul_f32 v[30:31], v[26:27], v[16:17]
    v_pk_fma_f32 v[28:29], v[24:25], v[16:17], v[14:15] neg_lo:[0,0,1] neg_hi:[0,0,1]
    v_pk_fma_f32 v[30:31], v[24:25], v[18:19], v[30:31]
    v_cvt_pk_bf16_f32 v98, v28, v29
    v_cvt_pk_bf16_f32 v99, v30, v31
    v_mfma_f32_16x16x32_bf16 v[100:103], v[64:67], v[84:87], 0
    v_mfma_f32_16x16x32_bf16 v[104:107], v[68:71], v[88:91], 0
    v_mfma_f32_16x16x32_bf16 v[108:111], v[72:75], v[92:95], 0
    v_mfma_f32_16x16x32_bf16 v[112:115], v[76:79], v[96:99], 0
    v_mfma_f32_16x16x32_bf16 v[116:119], v[80:83], v[96:99], 0
    s_waitcnt vmcnt(3)
    s_nop 0
    v_dot2_f32_bf16 v168, v160, s56, v168
    v_dot2_f32_bf16 v169, v160, v160, v169
    v_dot2_f32_bf16 v168, v161, s56, v168
    v_dot2_f32_bf16 v169, v161, v161, v169
    v_dot2_f32_bf16 v168, v162, s56, v168
    v_dot2_f32_bf16 v169, v162, v162, v169
    v_dot2_f32_bf16 v168, v163, s56, v168
    v_dot2_f32_bf16 v169, v163, v163, v169
    v_dot2_f32_bf16 v168, v164, s56, v168
    v_dot2_f32_bf16 v169, v164, v164, v169
    v_dot2_f32_bf16 v168, v165, s56, v168
    v_dot2_f32_bf16 v169, v165, v165, v169
    v_dot2_f32_bf16 v168, v166, s56, v168
    v_dot2_f32_bf16 v169, v166, v166, v169
    v_dot2_f32_bf16 v168, v167, s56, v168
    v_dot2_f32_bf16 v169, v167, v167, v169
    s_nop 1
    v_add_f32_dpp v168, v168, v168 quad_perm:[1,0,3,2] row_mask:0xf bank_mask:0xf
    v_add_f32_dpp v169, v169, v169 quad_perm:[1,0,3,2] row_mask:0xf bank_mask:0xf
    s_nop 0
    v_add_f32_dpp v168, v168, v168 quad_perm:[2,3,0,1] row_mask:0xf bank_mask:0xf
    v_add_f32_dpp v169, v169, v169 quad_perm:[2,3,0,1] row_mask:0xf bank_mask:0xf
    s_nop 0
    v_add_f32_dpp v168, v168, v168 row_half_mirror row_mask:0xf bank_mask:0xf
    v_add_f32_dpp v169, v169, v169 row_half_mirror row_mask:0xf bank_mask:0xf
    s_nop 0
    v_add_f32_dpp v168, v168, v168 row_mirror row_mask:0xf bank_mask:0xf
    v_add_f32_dpp v169, v169, v169 row_mirror row_mask:0xf bank_mask:0xf
    v_mov_b32 v170, v168
    v_mov_b32 v171, v169
    s_nop 0
    v_permlane16_swap_b32 v168, v170
    v_permlane16_swap_b32 v169, v171
    v_add_f32 v168, v168, v170
    v_add_f32_e64 v169, v169, v171
    v_mul_f32 v168, 0x3b000000, v168
    v_mul_f32 v169, 0x3b000000, v169
    v_fma_f32 v169, -v168, v168, v169
    v_max_f32_e64 v169, 0, v169
    v_cvt_pk_bf16_f32 v192, 0, v168
    v_cvt_pk_bf16_f32 v169, 0, v169
    v_add_f32 v169, 0x3727c5ac, v169
    v_cvt_pk_bf16_f32 v169, 0, v169
    v_sqrt_f32 v169, v169
    s_nop 0
    v_cvt_pk_bf16_f32 v194, 0, v169
    v_rcp_f32 v172, v194
    v_lshlrev_b32 v174, 16, v160
    v_and_b32_e64 v175, s59, v160
    v_pk_add_f32 v[174:175], v[174:175], v[192:193] op_sel_hi:[1,0] neg_lo:[0,1] neg_hi:[0,1]
    v_pk_mul_f32 v[174:175], v[174:175], v[172:173] op_sel_hi:[1,0]
    v_cvt_pk_bf16_f32 v160, v174, v175
    v_lshlrev_b32 v176, 16, v161
    v_and_b32 v177, s59, v161
    v_pk_add_f32 v[176:177], v[176:177], v[192:193] op_sel_hi:[1,0] neg_lo:[0,1] neg_hi:[0,1]
    v_pk_mul_f32 v[176:177], v[176:177], v[172:173] op_sel_hi:[1,0]
    v_cvt_pk_bf16_f32 v161, v176, v177
    v_lshlrev_b32 v178, 16, v162
    v_and_b32 v179, s59, v162
    v_pk_add_f32 v[178:179], v[178:179], v[192:193] op_sel_hi:[1,0] neg_lo:[0,1] neg_hi:[0,1]
    v_pk_mul_f32 v[178:179], v[178:179], v[172:173] op_sel_hi:[1,0]
    v_cvt_pk_bf16_f32 v162, v178, v179
    v_lshlrev_b32 v180, 16, v163
    v_and_b32 v181, s59, v163
    v_pk_add_f32 v[180:181], v[180:181], v[192:193] op_sel_hi:[1,0] neg_lo:[0,1] neg_hi:[0,1]
    v_pk_mul_f32 v[180:181], v[180:181], v[172:173] op_sel_hi:[1,0]
    v_cvt_pk_bf16_f32 v163, v180, v181
    ds_write_b128 v182, v[160:163]
    v_lshlrev_b32 v174, 16, v164
    v_and_b32 v175, s59, v164
    v_pk_add_f32 v[174:175], v[174:175], v[192:193] op_sel_hi:[1,0] neg_lo:[0,1] neg_hi:[0,1]
    v_pk_mul_f32 v[174:175], v[174:175], v[172:173] op_sel_hi:[1,0]
    v_cvt_pk_bf16_f32 v164, v174, v175
    v_lshlrev_b32 v176, 16, v165
    v_and_b32 v177, s59, v165
    v_pk_add_f32 v[176:177], v[176:177], v[192:193] op_sel_hi:[1,0] neg_lo:[0,1] neg_hi:[0,1]
    v_pk_mul_f32 v[176:177], v[176:177], v[172:173] op_sel_hi:[1,0]
    v_cvt_pk_bf16_f32 v165, v176, v177
    v_lshlrev_b32 v178, 16, v166
    v_and_b32 v179, s59, v166
    v_pk_add_f32 v[178:179], v[178:179], v[192:193] op_sel_hi:[1,0] neg_lo:[0,1] neg_hi:[0,1]
    v_pk_mul_f32 v[178:179], v[178:179], v[172:173] op_sel_hi:[1,0]
    v_cvt_pk_bf16_f32 v166, v178, v179
    v_lshlrev_b32 v180, 16, v167
    v_and_b32 v181, s59, v167
    v_pk_add_f32 v[180:181], v[180:181], v[192:193] op_sel_hi:[1,0] neg_lo:[0,1] neg_hi:[0,1]
    v_pk_mul_f32 v[180:181], v[180:181], v[172:173] op_sel_hi:[1,0]
    v_cvt_pk_bf16_f32 v167, v180, v181
    ds_write_b128 v182, v[164:167] offset:512
    v_mov_b32 v193, v172
    v_lshlrev_b32_e64 v196, 4, v5
    s_lshl_b32 s71, s3, 7
    s_lshl_b32 s72, s28, 5
    s_add_u32 s71, s71, s72
    s_add_u32 s71, s71, 0xc60000
    s_waitcnt lgkmcnt(0)
    s_barrier
    ds_read_b64_tr_b16 v[184:185], v183
    ds_read_b64_tr_b16 v[186:187], v183 offset:4352
    ds_read_b64_tr_b16 v[188:189], v183 offset:128
    ds_read_b64_tr_b16 v[190:191], v183 offset:4480
    s_waitcnt lgkmcnt(2)
    buffer_store_dwordx4 v[184:187], v7, s[44:47], s55 offen sc1
    s_waitcnt lgkmcnt(0)
    buffer_store_dwordx4 v[188:191], v7, s[44:47], s55 offen offset:1024 sc1
    s_waitcnt vmcnt(2)
    s_mov_b32 s70, 262144
L_K_tag:
    v_cmp_eq_u32 vcc, 0, v123
    s_cbranch_vccz L_K_tag_ok
    s_sub_u32 s70, s70, 1
    s_cbranch_scc1 L_K_tag_ok
    s_sleep 2
    global_load_dword v123, v122, s[24:25] sc1
    s_waitcnt vmcnt(0)
    s_branch L_K_tag
L_K_tag_ok:
    v_mov_b32 v195, v123
    v_readfirstlane_b32 s51, v123
    s_mov_b32 exec_lo, 1
    s_mov_b32 exec_hi, 1
    buffer_store_dwordx4 v[192:195], v196, s[44:47], s71 offen sc1
    s_mov_b64 exec, -1
    v_mul_f32_dpp v8, v48, v56 row_newbcast:4 row_mask:0xf bank_mask:0xf
    v_mul_f32_dpp v9, v48, v56 row_newbcast:5 row_mask:0xf bank_mask:0xf
    v_mul_f32_dpp v12, v49, v56 row_newbcast:4 row_mask:0xf bank_mask:0xf
    v_mul_f32_dpp v13, v49, v56 row_newbcast:5 row_mask:0xf bank_mask:0xf
    v_exp_f32 v8, v8
    v_exp_f32 v9, v9
    v_cos_f32 v10, v12
    v_cos_f32 v11, v13
    v_sin_f32 v12, v12
    v_sin_f32_e64 v13, v13
    v_pk_mul_f32 v[16:17], v[8:9], v[10:11]
    v_pk_mul_f32 v[18:19], v[8:9], v[12:13]
    v_cvt_pk_bf16_f32 v64, v16, v17
    v_cvt_pk_bf16_f32 v65, -v18, -v19
    v_pk_mul_f32 v[14:15], v[18:19], v[18:19]
    v_pk_mul_f32 v[22:23], v[16:17], v[18:19]
    v_pk_fma_f32 v[20:21], v[16:17], v[16:17], v[14:15] neg_lo:[0,0,1] neg_hi:[0,0,1]
    v_pk_add_f32 v[22:23], v[22:23], v[22:23]
    v_cvt_pk_bf16_f32 v68, v20, v21
    v_cvt_pk_bf16_f32 v69, -v22, -v23
    v_pk_mul_f32 v[14:15], v[22:23], v[22:23]
    v_pk_mul_f32 v[18:19], v[20:21], v[22:23]
    v_pk_fma_f32 v[16:17], v[20:21], v[20:21], v[14:15] neg_lo:[0,0,1] neg_hi:[0,0,1]
    v_pk_add_f32 v[18:19], v[18:19], v[18:19]
    v_cvt_pk_bf16_f32 v72, v16, v17
    v_cvt_pk_bf16_f32 v73, -v18, -v19
    v_pk_mul_f32 v[14:15], v[18:19], v[18:19]
    v_pk_mul_f32 v[22:23], v[16:17], v[18:19]
    v_pk_fma_f32 v[20:21], v[16:17], v[16:17], v[14:15] neg_lo:[0,0,1] neg_hi:[0,0,1]
    v_pk_add_f32 v[22:23], v[22:23], v[22:23]
    v_cvt_pk_bf16_f32 v76, v20, v21
    v_cvt_pk_bf16_f32 v77, -v22, -v23
    v_pk_mul_f32 v[14:15], v[22:23], v[22:23]
    v_pk_mul_f32 v[18:19], v[20:21], v[22:23]
    v_pk_fma_f32 v[16:17], v[20:21], v[20:21], v[14:15] neg_lo:[0,0,1] neg_hi:[0,0,1]
    v_pk_add_f32 v[18:19], v[18:19], v[18:19]
    s_nop 0
    v_mul_f32_dpp v24, v50, v16 row_newbcast:4 row_mask:0xf bank_mask:0xf
    v_mul_f32_dpp v26, v50, v18 row_newbcast:4 row_mask:0xf bank_mask:0xf
    s_nop 0
    v_fmac_f32_dpp v24, -v51, v18 row_newbcast:4 row_mask:0xf bank_mask:0xf
    v_fmac_f32_dpp v26, v51, v16 row_newbcast:4 row_mask:0xf bank_mask:0xf
    v_mul_f32_dpp v25, v50, v17 row_newbcast:5 row_mask:0xf bank_mask:0xf
    v_mul_f32_dpp v27, v50, v19 row_newbcast:5 row_mask:0xf bank_mask:0xf
    s_nop 0
    s_nop 0
    v_fmac_f32_dpp v25, -v51, v19 row_newbcast:5 row_mask:0xf bank_mask:0xf
    v_fmac_f32_dpp v27, v51, v17 row_newbcast:5 row_mask:0xf bank_mask:0xf
    v_cvt_pk_bf16_f32 v84, v24, v25
    v_cvt_pk_bf16_f32 v85, v26, v27
    v_pk_mul_f32 v[14:15], v[26:27], v[18:19]
    v_pk_mul_f32 v[30:31], v[26:27], v[16:17]
    v_pk_fma_f32 v[28:29], v[24:25], v[16:17], v[14:15] neg_lo:[0,0,1] neg_hi:[0,0,1]
    v_pk_fma_f32 v[30:31], v[24:25], v[18:19], v[30:31]
    v_cvt_pk_bf16_f32 v88, v28, v29
    v_cvt_pk_bf16_f32 v89, v30, v31
    v_pk_mul_f32 v[14:15], v[18:19], v[18:19]
    v_pk_mul_f32 v[22:23], v[16:17], v[18:19]
    v_pk_fma_f32 v[20:21], v[16:17], v[16:17], v[14:15] neg_lo:[0,0,1] neg_hi:[0,0,1]
    v_pk_add_f32 v[22:23], v[22:23], v[22:23]
    v_pk_mul_f32 v[14:15], v[30:31], v[22:23]
    v_pk_mul_f32 v[26:27], v[30:31], v[20:21]
    v_pk_fma_f32 v[24:25], v[28:29], v[20:21], v[14:15] neg_lo:[0,0,1] neg_hi:[0,0,1]
    v_pk_fma_f32 v[26:27], v[28:29], v[22:23], v[26:27]
    v_cvt_pk_bf16_f32 v92, v24, v25
    v_cvt_pk_bf16_f32 v93, v26, v27
    v_pk_mul_f32 v[14:15], v[22:23], v[22:23]
    v_pk_mul_f32 v[18:19], v[20:21], v[22:23]
    v_pk_fma_f32 v[16:17], v[20:21], v[20:21], v[14:15] neg_lo:[0,0,1] neg_hi:[0,0,1]
    v_pk_add_f32 v[18:19], v[18:19], v[18:19]
    v_cvt_pk_bf16_f32 v80, v16, v17
    v_cvt_pk_bf16_f32 v81, -v18, -v19
    v_pk_mul_f32 v[14:15], v[26:27], v[18:19]
    v_pk_mul_f32 v[30:31], v[26:27], v[16:17]
    v_pk_fma_f32 v[28:29], v[24:25], v[16:17], v[14:15] neg_lo:[0,0,1] neg_hi:[0,0,1]
    v_pk_fma_f32 v[30:31], v[24:25], v[18:19], v[30:31]
    v_cvt_pk_bf16_f32 v96, v28, v29
    v_cvt_pk_bf16_f32 v97, v30, v31
    s_waitcnt vmcnt(1)
    s_barrier
    s_cmp_lg_u32 s28, 0
    s_cbranch_scc1 L_K_f1done
    s_lshl_b32 s71, s3, 7
    s_add_u32 s71, s71, 0xc00000
    s_mov_b64 exec, 1
    buffer_store_dword v123, v122, s[44:47], s71 offen sc1
    s_mov_b64 exec, -1
L_K_f1done:
    s_mov_b32 s64, s22
    s_mov_b32 s65, s23
    s_mov_b32 s66, 0x158000
    s_mov_b32 s67, 0x20000
    buffer_load_dwordx4 v[60:63], v7, s[64:67], s57 offen
    buffer_load_dwordx4 v[60:63], v7, s[64:67], s58 offen
    v_mul_f32_dpp v8, v48, v56 row_newbcast:6 row_mask:0xf bank_mask:0xf
    v_mul_f32_dpp v9, v48, v56 row_newbcast:7 row_mask:0xf bank_mask:0xf
    v_mul_f32_dpp v12, v49, v56 row_newbcast:6 row_mask:0xf bank_mask:0xf
    v_mul_f32_dpp v13, v49, v56 row_newbcast:7 row_mask:0xf bank_mask:0xf
    v_exp_f32 v8, v8
    v_exp_f32 v9, v9
    v_cos_f32 v10, v12
    v_cos_f32 v11, v13
    v_sin_f32 v12, v12
    v_sin_f32_e64 v13, v13
    v_pk_mul_f32 v[16:17], v[8:9], v[10:11]
    v_pk_mul_f32 v[18:19], v[8:9], v[12:13]
    v_cvt_pk_bf16_f32 v66, v16, v17
    v_cvt_pk_bf16_f32 v67, -v18, -v19
    v_pk_mul_f32 v[14:15], v[18:19], v[18:19]
    v_pk_mul_f32 v[22:23], v[16:17], v[18:19]
    v_pk_fma_f32 v[20:21], v[16:17], v[16:17], v[14:15] neg_lo:[0,0,1] neg_hi:[0,0,1]
    v_pk_add_f32 v[22:23], v[22:23], v[22:23]
    v_cvt_pk_bf16_f32 v70, v20, v21
    v_cvt_pk_bf16_f32 v71, -v22, -v23
    v_pk_mul_f32 v[14:15], v[22:23], v[22:23]
    v_pk_mul_f32 v[18:19], v[20:21], v[22:23]
    v_pk_fma_f32 v[16:17], v[20:21], v[20:21], v[14:15] neg_lo:[0,0,1] neg_hi:[0,0,1]
    v_pk_add_f32 v[18:19], v[18:19], v[18:19]
    v_cvt_pk_bf16_f32 v74, v16, v17
    v_cvt_pk_bf16_f32 v75, -v18, -v19
    v_pk_mul_f32 v[14:15], v[18:19], v[18:19]
    v_pk_mul_f32 v[22:23], v[16:17], v[18:19]
    v_pk_fma_f32 v[20:21], v[16:17], v[16:17], v[14:15] neg_lo:[0,0,1] neg_hi:[0,0,1]
    v_pk_add_f32 v[22:23], v[22:23], v[22:23]
    v_cvt_pk_bf16_f32 v78, v20, v21
    v_cvt_pk_bf16_f32 v79, -v22, -v23
    v_pk_mul_f32 v[14:15], v[22:23], v[22:23]
    v_pk_mul_f32 v[18:19], v[20:21], v[22:23]
    v_pk_fma_f32 v[16:17], v[20:21], v[20:21], v[14:15] neg_lo:[0,0,1] neg_hi:[0,0,1]
    v_pk_add_f32 v[18:19], v[18:19], v[18:19]
    s_nop 0
    v_mul_f32_dpp v24, v50, v16 row_newbcast:6 row_mask:0xf bank_mask:0xf
    v_mul_f32_dpp v26, v50, v18 row_newbcast:6 row_mask:0xf bank_mask:0xf
    s_nop 0
    v_fmac_f32_dpp v24, -v51, v18 row_newbcast:6 row_mask:0xf bank_mask:0xf
    v_fmac_f32_dpp v26, v51, v16 row_newbcast:6 row_mask:0xf bank_mask:0xf
    v_mul_f32_dpp v25, v50, v17 row_newbcast:7 row_mask:0xf bank_mask:0xf
    v_mul_f32_dpp v27, v50, v19 row_newbcast:7 row_mask:0xf bank_mask:0xf
    s_nop 0
    s_nop 0
    v_fmac_f32_dpp v25, -v51, v19 row_newbcast:7 row_mask:0xf bank_mask:0xf
    v_fmac_f32_dpp v27, v51, v17 row_newbcast:7 row_mask:0xf bank_mask:0xf
    v_cvt_pk_bf16_f32 v86, v24, v25
    v_cvt_pk_bf16_f32 v87, v26, v27
    v_pk_mul_f32 v[14:15], v[26:27], v[18:19]
    v_pk_mul_f32 v[30:31], v[26:27], v[16:17]
    v_pk_fma_f32 v[28:29], v[24:25], v[16:17], v[14:15] neg_lo:[0,0,1] neg_hi:[0,0,1]
    v_pk_fma_f32 v[30:31], v[24:25], v[18:19], v[30:31]
    v_cvt_pk_bf16_f32 v90, v28, v29
    v_cvt_pk_bf16_f32 v91, v30, v31
    v_pk_mul_f32 v[14:15], v[18:19], v[18:19]
    v_pk_mul_f32 v[22:23], v[16:17], v[18:19]
    v_pk_fma_f32 v[20:21], v[16:17], v[16:17], v[14:15] neg_lo:[0,0,1] neg_hi:[0,0,1]
    v_pk_add_f32 v[22:23], v[22:23], v[22:23]
    v_pk_mul_f32 v[14:15], v[30:31], v[22:23]
    v_pk_mul_f32 v[26:27], v[30:31], v[20:21]
    v_pk_fma_f32 v[24:25], v[28:29], v[20:21], v[14:15] neg_lo:[0,0,1] neg_hi:[0,0,1]
    v_pk_fma_f32 v[26:27], v[28:29], v[22:23], v[26:27]
    v_cvt_pk_bf16_f32 v94, v24, v25
    v_cvt_pk_bf16_f32 v95, v26, v27
    v_pk_mul_f32 v[14:15], v[22:23], v[22:23]
    v_pk_mul_f32 v[18:19], v[20:21], v[22:23]
    v_pk_fma_f32 v[16:17], v[20:21], v[20:21], v[14:15] neg_lo:[0,0,1] neg_hi:[0,0,1]
    v_pk_add_f32 v[18:19], v[18:19], v[18:19]
    v_cvt_pk_bf16_f32 v82, v16, v17
    v_cvt_pk_bf16_f32 v83, -v18, -v19
    v_pk_mul_f32 v[14:15], v[26:27], v[18:19]
    v_pk_mul_f32 v[30:31], v[26:27], v[16:17]
    v_pk_fma_f32 v[28:29], v[24:25], v[16:17], v[14:15] neg_lo:[0,0,1] neg_hi:[0,0,1]
    v_pk_fma_f32 v[30:31], v[24:25], v[18:19], v[30:31]
    v_cvt_pk_bf16_f32 v98, v28, v29
    v_cvt_pk_bf16_f32 v99, v30, v31
    v_mfma_f32_16x16x32_bf16 v[100:103], v[64:67], v[84:87], v[100:103]
    v_mfma_f32_16x16x32_bf16 v[104:107], v[68:71], v[88:91], v[104:107]
    v_mfma_f32_16x16x32_bf16 v[108:111], v[72:75], v[92:95], v[108:111]
    v_mfma_f32_16x16x32_bf16 v[112:115], v[76:79], v[96:99], v[112:115]
    v_mfma_f32_16x16x32_bf16 v[116:119], v[80:83], v[96:99], v[116:119]
    v_mul_f32_dpp v8, v48, v56 row_newbcast:8 row_mask:0xf bank_mask:0xf
    v_mul_f32_dpp v9, v48, v56 row_newbcast:9 row_mask:0xf bank_mask:0xf
    v_mul_f32_dpp v12, v49, v56 row_newbcast:8 row_mask:0xf bank_mask:0xf
    v_mul_f32_dpp v13, v49, v56 row_newbcast:9 row_mask:0xf bank_mask:0xf
    v_exp_f32 v8, v8
    v_exp_f32 v9, v9
    v_cos_f32 v10, v12
    v_cos_f32 v11, v13
    v_sin_f32 v12, v12
    v_sin_f32 v13, v13
    v_pk_mul_f32 v[16:17], v[8:9], v[10:11]
    v_pk_mul_f32 v[18:19], v[8:9], v[12:13]
    v_cvt_pk_bf16_f32 v64, v16, v17
    v_cvt_pk_bf16_f32 v65, -v18, -v19
    v_pk_mul_f32 v[14:15], v[18:19], v[18:19]
    v_pk_mul_f32 v[22:23], v[16:17], v[18:19]
    v_pk_fma_f32 v[20:21], v[16:17], v[16:17], v[14:15] neg_lo:[0,0,1] neg_hi:[0,0,1]
    v_pk_add_f32 v[22:23], v[22:23], v[22:23]
    v_cvt_pk_bf16_f32 v68, v20, v21
    v_cvt_pk_bf16_f32 v69, -v22, -v23
    v_pk_mul_f32 v[14:15], v[22:23], v[22:23]
    v_pk_mul_f32 v[18:19], v[20:21], v[22:23]
    v_pk_fma_f32 v[16:17], v[20:21], v[20:21], v[14:15] neg_lo:[0,0,1] neg_hi:[0,0,1]
    v_pk_add_f32 v[18:19], v[18:19], v[18:19]
    v_cvt_pk_bf16_f32 v72, v16, v17
    v_cvt_pk_bf16_f32 v73, -v18, -v19
    v_pk_mul_f32 v[14:15], v[18:19], v[18:19]
    v_pk_mul_f32 v[22:23], v[16:17], v[18:19]
    v_pk_fma_f32 v[20:21], v[16:17], v[16:17], v[14:15] neg_lo:[0,0,1] neg_hi:[0,0,1]
    v_pk_add_f32 v[22:23], v[22:23], v[22:23]
    v_cvt_pk_bf16_f32 v76, v20, v21
    v_cvt_pk_bf16_f32 v77, -v22, -v23
    v_pk_mul_f32 v[14:15], v[22:23], v[22:23]
    v_pk_mul_f32 v[18:19], v[20:21], v[22:23]
    v_pk_fma_f32 v[16:17], v[20:21], v[20:21], v[14:15] neg_lo:[0,0,1] neg_hi:[0,0,1]
    v_pk_add_f32 v[18:19], v[18:19], v[18:19]
    s_nop 0
    v_mul_f32_dpp v24, v50, v16 row_newbcast:8 row_mask:0xf bank_mask:0xf
    v_mul_f32_dpp v26, v50, v18 row_newbcast:8 row_mask:0xf bank_mask:0xf
    s_nop 0
    v_fmac_f32_dpp v24, -v51, v18 row_newbcast:8 row_mask:0xf bank_mask:0xf
    v_fmac_f32_dpp v26, v51, v16 row_newbcast:8 row_mask:0xf bank_mask:0xf
    v_mul_f32_dpp v25, v50, v17 row_newbcast:9 row_mask:0xf bank_mask:0xf
    v_mul_f32_dpp v27, v50, v19 row_newbcast:9 row_mask:0xf bank_mask:0xf
    s_nop 0
    s_nop 0
    v_fmac_f32_dpp v25, -v51, v19 row_newbcast:9 row_mask:0xf bank_mask:0xf
    v_fmac_f32_dpp v27, v51, v17 row_newbcast:9 row_mask:0xf bank_mask:0xf
    v_cvt_pk_bf16_f32 v84, v24, v25
    v_cvt_pk_bf16_f32 v85, v26, v27
    v_pk_mul_f32 v[14:15], v[26:27], v[18:19]
    v_pk_mul_f32 v[30:31], v[26:27], v[16:17]
    v_pk_fma_f32 v[28:29], v[24:25], v[16:17], v[14:15] neg_lo:[0,0,1] neg_hi:[0,0,1]
    v_pk_fma_f32 v[30:31], v[24:25], v[18:19], v[30:31]
    v_cvt_pk_bf16_f32 v88, v28, v29
    v_cvt_pk_bf16_f32 v89, v30, v31
    v_pk_mul_f32 v[14:15], v[18:19], v[18:19]
    v_pk_mul_f32 v[22:23], v[16:17], v[18:19]
    v_pk_fma_f32 v[20:21], v[16:17], v[16:17], v[14:15] neg_lo:[0,0,1] neg_hi:[0,0,1]
    v_pk_add_f32 v[22:23], v[22:23], v[22:23]
    v_pk_mul_f32 v[14:15], v[30:31], v[22:23]
    v_pk_mul_f32 v[26:27], v[30:31], v[20:21]
    v_pk_fma_f32 v[24:25], v[28:29], v[20:21], v[14:15] neg_lo:[0,0,1] neg_hi:[0,0,1]
    v_pk_fma_f32 v[26:27], v[28:29], v[22:23], v[26:27]
    v_cvt_pk_bf16_f32 v92, v24, v25
    v_cvt_pk_bf16_f32 v93, v26, v27
    v_pk_mul_f32 v[14:15], v[22:23], v[22:23]
    v_pk_mul_f32 v[18:19], v[20:21], v[22:23]
    v_pk_fma_f32 v[16:17], v[20:21], v[20:21], v[14:15] neg_lo:[0,0,1] neg_hi:[0,0,1]
    v_pk_add_f32 v[18:19], v[18:19], v[18:19]
    v_cvt_pk_bf16_f32 v80, v16, v17
    v_cvt_pk_bf16_f32 v81, -v18, -v19
    v_pk_mul_f32 v[14:15], v[26:27], v[18:19]
    v_pk_mul_f32 v[30:31], v[26:27], v[16:17]
    v_pk_fma_f32 v[28:29], v[24:25], v[16:17], v[14:15] neg_lo:[0,0,1] neg_hi:[0,0,1]
    v_pk_fma_f32 v[30:31], v[24:25], v[18:19], v[30:31]
    v_cvt_pk_bf16_f32 v96, v28, v29
    v_cvt_pk_bf16_f32 v97, v30, v31
    v_mul_f32_dpp v8, v48, v56 row_newbcast:10 row_mask:0xf bank_mask:0xf
    v_mul_f32_dpp v9, v48, v56 row_newbcast:11 row_mask:0xf bank_mask:0xf
    v_mul_f32_dpp v12, v49, v56 row_newbcast:10 row_mask:0xf bank_mask:0xf
    v_mul_f32_dpp v13, v49, v56 row_newbcast:11 row_mask:0xf bank_mask:0xf
    v_exp_f32 v8, v8
    v_exp_f32 v9, v9
    v_cos_f32 v10, v12
    v_cos_f32 v11, v13
    v_sin_f32 v12, v12
    v_sin_f32 v13, v13
    v_pk_mul_f32 v[16:17], v[8:9], v[10:11]
    v_pk_mul_f32 v[18:19], v[8:9], v[12:13]
    v_cvt_pk_bf16_f32 v66, v16, v17
    v_cvt_pk_bf16_f32 v67, -v18, -v19
    v_pk_mul_f32 v[14:15], v[18:19], v[18:19]
    v_pk_mul_f32 v[22:23], v[16:17], v[18:19]
    v_pk_fma_f32 v[20:21], v[16:17], v[16:17], v[14:15] neg_lo:[0,0,1] neg_hi:[0,0,1]
    v_pk_add_f32 v[22:23], v[22:23], v[22:23]
    v_cvt_pk_bf16_f32 v70, v20, v21
    v_cvt_pk_bf16_f32 v71, -v22, -v23
    v_pk_mul_f32 v[14:15], v[22:23], v[22:23]
    v_pk_mul_f32 v[18:19], v[20:21], v[22:23]
    v_pk_fma_f32 v[16:17], v[20:21], v[20:21], v[14:15] neg_lo:[0,0,1] neg_hi:[0,0,1]
    v_pk_add_f32 v[18:19], v[18:19], v[18:19]
    v_cvt_pk_bf16_f32 v74, v16, v17
    v_cvt_pk_bf16_f32 v75, -v18, -v19
    v_pk_mul_f32 v[14:15], v[18:19], v[18:19]
    v_pk_mul_f32 v[22:23], v[16:17], v[18:19]
    v_pk_fma_f32 v[20:21], v[16:17], v[16:17], v[14:15] neg_lo:[0,0,1] neg_hi:[0,0,1]
    v_pk_add_f32 v[22:23], v[22:23], v[22:23]
    v_cvt_pk_bf16_f32 v78, v20, v21
    v_cvt_pk_bf16_f32 v79, -v22, -v23
    v_pk_mul_f32 v[14:15], v[22:23], v[22:23]
    v_pk_mul_f32 v[18:19], v[20:21], v[22:23]
    v_pk_fma_f32 v[16:17], v[20:21], v[20:21], v[14:15] neg_lo:[0,0,1] neg_hi:[0,0,1]
    v_pk_add_f32 v[18:19], v[18:19], v[18:19]
    s_nop 0
    v_mul_f32_dpp v24, v50, v16 row_newbcast:10 row_mask:0xf bank_mask:0xf
    v_mul_f32_dpp v26, v50, v18 row_newbcast:10 row_mask:0xf bank_mask:0xf
    s_nop 0
    v_fmac_f32_dpp v24, -v51, v18 row_newbcast:10 row_mask:0xf bank_mask:0xf
    v_fmac_f32_dpp v26, v51, v16 row_newbcast:10 row_mask:0xf bank_mask:0xf
    v_mul_f32_dpp v25, v50, v17 row_newbcast:11 row_mask:0xf bank_mask:0xf
    v_mul_f32_dpp v27, v50, v19 row_newbcast:11 row_mask:0xf bank_mask:0xf
    s_nop 0
    s_nop 0
    v_fmac_f32_dpp v25, -v51, v19 row_newbcast:11 row_mask:0xf bank_mask:0xf
    v_fmac_f32_dpp v27, v51, v17 row_newbcast:11 row_mask:0xf bank_mask:0xf
    v_cvt_pk_bf16_f32 v86, v24, v25
    v_cvt_pk_bf16_f32 v87, v26, v27
    v_pk_mul_f32 v[14:15], v[26:27], v[18:19]
    v_pk_mul_f32 v[30:31], v[26:27], v[16:17]
    v_pk_fma_f32 v[28:29], v[24:25], v[16:17], v[14:15] neg_lo:[0,0,1] neg_hi:[0,0,1]
    v_pk_fma_f32 v[30:31], v[24:25], v[18:19], v[30:31]
    v_cvt_pk_bf16_f32 v90, v28, v29
    v_cvt_pk_bf16_f32 v91, v30, v31
    v_pk_mul_f32 v[14:15], v[18:19], v[18:19]
    v_pk_mul_f32 v[22:23], v[16:17], v[18:19]
    v_pk_fma_f32 v[20:21], v[16:17], v[16:17], v[14:15] neg_lo:[0,0,1] neg_hi:[0,0,1]
    v_pk_add_f32 v[22:23], v[22:23], v[22:23]
    v_pk_mul_f32 v[14:15], v[30:31], v[22:23]
    v_pk_mul_f32 v[26:27], v[30:31], v[20:21]
    v_pk_fma_f32 v[24:25], v[28:29], v[20:21], v[14:15] neg_lo:[0,0,1] neg_hi:[0,0,1]
    v_pk_fma_f32 v[26:27], v[28:29], v[22:23], v[26:27]
    v_cvt_pk_bf16_f32 v94, v24, v25
    v_cvt_pk_bf16_f32 v95, v26, v27
    v_pk_mul_f32 v[14:15], v[22:23], v[22:23]
    v_pk_mul_f32 v[18:19], v[20:21], v[22:23]
    v_pk_fma_f32 v[16:17], v[20:21], v[20:21], v[14:15] neg_lo:[0,0,1] neg_hi:[0,0,1]
    v_pk_add_f32 v[18:19], v[18:19], v[18:19]
    v_cvt_pk_bf16_f32 v82, v16, v17
    v_cvt_pk_bf16_f32 v83, -v18, -v19
    v_pk_mul_f32 v[14:15], v[26:27], v[18:19]
    v_pk_mul_f32 v[30:31], v[26:27], v[16:17]
    v_pk_fma_f32 v[28:29], v[24:25], v[16:17], v[14:15] neg_lo:[0,0,1] neg_hi:[0,0,1]
    v_pk_fma_f32 v[30:31], v[24:25], v[18:19], v[30:31]
    v_cvt_pk_bf16_f32 v98, v28, v29
    v_cvt_pk_bf16_f32 v99, v30, v31
    v_mfma_f32_16x16x32_bf16 v[100:103], v[64:67], v[84:87], v[100:103]
    v_mfma_f32_16x16x32_bf16 v[104:107], v[68:71], v[88:91], v[104:107]
    v_mfma_f32_16x16x32_bf16 v[108:111], v[72:75], v[92:95], v[108:111]
    v_mfma_f32_16x16x32_bf16 v[112:115], v[76:79], v[96:99], v[112:115]
    v_mfma_f32_16x16x32_bf16 v[116:119], v[80:83], v[96:99], v[116:119]
    v_mul_f32_dpp v8, v48, v56 row_newbcast:12 row_mask:0xf bank_mask:0xf
    v_mul_f32_dpp v9, v48, v56 row_newbcast:13 row_mask:0xf bank_mask:0xf
    v_mul_f32_dpp v12, v49, v56 row_newbcast:12 row_mask:0xf bank_mask:0xf
    v_mul_f32_dpp v13, v49, v56 row_newbcast:13 row_mask:0xf bank_mask:0xf
    v_exp_f32 v8, v8
    v_exp_f32 v9, v9
    v_cos_f32 v10, v12
    v_cos_f32 v11, v13
    v_sin_f32 v12, v12
    v_sin_f32 v13, v13
    v_pk_mul_f32 v[16:17], v[8:9], v[10:11]
    v_pk_mul_f32 v[18:19], v[8:9], v[12:13]
    v_cvt_pk_bf16_f32 v64, v16, v17
    v_cvt_pk_bf16_f32 v65, -v18, -v19
    v_pk_mul_f32 v[14:15], v[18:19], v[18:19]
    v_pk_mul_f32 v[22:23], v[16:17], v[18:19]
    v_pk_fma_f32 v[20:21], v[16:17], v[16:17], v[14:15] neg_lo:[0,0,1] neg_hi:[0,0,1]
    v_pk_add_f32 v[22:23], v[22:23], v[22:23]
    v_cvt_pk_bf16_f32 v68, v20, v21
    v_cvt_pk_bf16_f32 v69, -v22, -v23
    v_pk_mul_f32 v[14:15], v[22:23], v[22:23]
    v_pk_mul_f32 v[18:19], v[20:21], v[22:23]
    v_pk_fma_f32 v[16:17], v[20:21], v[20:21], v[14:15] neg_lo:[0,0,1] neg_hi:[0,0,1]
    v_pk_add_f32 v[18:19], v[18:19], v[18:19]
    v_cvt_pk_bf16_f32 v72, v16, v17
    v_cvt_pk_bf16_f32 v73, -v18, -v19
    v_pk_mul_f32 v[14:15], v[18:19], v[18:19]
    v_pk_mul_f32 v[22:23], v[16:17], v[18:19]
    v_pk_fma_f32 v[20:21], v[16:17], v[16:17], v[14:15] neg_lo:[0,0,1] neg_hi:[0,0,1]
    v_pk_add_f32 v[22:23], v[22:23], v[22:23]
    v_cvt_pk_bf16_f32 v76, v20, v21
    v_cvt_pk_bf16_f32 v77, -v22, -v23
    v_pk_mul_f32 v[14:15], v[22:23], v[22:23]
    v_pk_mul_f32 v[18:19], v[20:21], v[22:23]
    v_pk_fma_f32 v[16:17], v[20:21], v[20:21], v[14:15] neg_lo:[0,0,1] neg_hi:[0,0,1]
    v_pk_add_f32 v[18:19], v[18:19], v[18:19]
    s_nop 0
    v_mul_f32_dpp v24, v50, v16 row_newbcast:12 row_mask:0xf bank_mask:0xf
    v_mul_f32_dpp v26, v50, v18 row_newbcast:12 row_mask:0xf bank_mask:0xf
    s_nop 0
    v_fmac_f32_dpp v24, -v51, v18 row_newbcast:12 row_mask:0xf bank_mask:0xf
    v_fmac_f32_dpp v26, v51, v16 row_newbcast:12 row_mask:0xf bank_mask:0xf
    v_mul_f32_dpp v25, v50, v17 row_newbcast:13 row_mask:0xf bank_mask:0xf
    v_mul_f32_dpp v27, v50, v19 row_newbcast:13 row_mask:0xf bank_mask:0xf
    s_nop 0
    s_nop 0
    v_fmac_f32_dpp v25, -v51, v19 row_newbcast:13 row_mask:0xf bank_mask:0xf
    v_fmac_f32_dpp v27, v51, v17 row_newbcast:13 row_mask:0xf bank_mask:0xf
    v_cvt_pk_bf16_f32 v84, v24, v25
    v_cvt_pk_bf16_f32 v85, v26, v27
    v_pk_mul_f32 v[14:15], v[26:27], v[18:19]
    v_pk_mul_f32 v[30:31], v[26:27], v[16:17]
    v_pk_fma_f32 v[28:29], v[24:25], v[16:17], v[14:15] neg_lo:[0,0,1] neg_hi:[0,0,1]
    v_pk_fma_f32 v[30:31], v[24:25], v[18:19], v[30:31]
    v_cvt_pk_bf16_f32 v88, v28, v29
    v_cvt_pk_bf16_f32 v89, v30, v31
    v_pk_mul_f32 v[14:15], v[18:19], v[18:19]
    v_pk_mul_f32 v[22:23], v[16:17], v[18:19]
    v_pk_fma_f32 v[20:21], v[16:17], v[16:17], v[14:15] neg_lo:[0,0,1] neg_hi:[0,0,1]
    v_pk_add_f32 v[22:23], v[22:23], v[22:23]
    v_pk_mul_f32 v[14:15], v[30:31], v[22:23]
    v_pk_mul_f32 v[26:27], v[30:31], v[20:21]
    v_pk_fma_f32 v[24:25], v[28:29], v[20:21], v[14:15] neg_lo:[0,0,1] neg_hi:[0,0,1]
    v_pk_fma_f32 v[26:27], v[28:29], v[22:23], v[26:27]
    v_cvt_pk_bf16_f32 v92, v24, v25
    v_cvt_pk_bf16_f32 v93, v26, v27
    v_pk_mul_f32 v[14:15], v[22:23], v[22:23]
    v_pk_mul_f32 v[18:19], v[20:21], v[22:23]
    v_pk_fma_f32 v[16:17], v[20:21], v[20:21], v[14:15] neg_lo:[0,0,1] neg_hi:[0,0,1]
    v_pk_add_f32 v[18:19], v[18:19], v[18:19]
    v_cvt_pk_bf16_f32 v80, v16, v17
    v_cvt_pk_bf16_f32 v81, -v18, -v19
    v_pk_mul_f32 v[14:15], v[26:27], v[18:19]
    v_pk_mul_f32 v[30:31], v[26:27], v[16:17]
    v_pk_fma_f32 v[28:29], v[24:25], v[16:17], v[14:15] neg_lo:[0,0,1] neg_hi:[0,0,1]
    v_pk_fma_f32 v[30:31], v[24:25], v[18:19], v[30:31]
    v_cvt_pk_bf16_f32 v96, v28, v29
    v_cvt_pk_bf16_f32 v97, v30, v31
    v_mul_f32_dpp v8, v48, v56 row_newbcast:14 row_mask:0xf bank_mask:0xf
    v_mul_f32_dpp v9, v48, v56 row_newbcast:15 row_mask:0xf bank_mask:0xf
    v_mul_f32_dpp v12, v49, v56 row_newbcast:14 row_mask:0xf bank_mask:0xf
    v_mul_f32_dpp v13, v49, v56 row_newbcast:15 row_mask:0xf bank_mask:0xf
    v_exp_f32 v8, v8
    v_exp_f32 v9, v9
    v_cos_f32 v10, v12
    v_cos_f32 v11, v13
    v_sin_f32 v12, v12
    v_sin_f32 v13, v13
    v_pk_mul_f32 v[16:17], v[8:9], v[10:11]
    v_pk_mul_f32 v[18:19], v[8:9], v[12:13]
    v_cvt_pk_bf16_f32 v66, v16, v17
    v_cvt_pk_bf16_f32 v67, -v18, -v19
    v_pk_mul_f32 v[14:15], v[18:19], v[18:19]
    v_pk_mul_f32 v[22:23], v[16:17], v[18:19]
    v_pk_fma_f32 v[20:21], v[16:17], v[16:17], v[14:15] neg_lo:[0,0,1] neg_hi:[0,0,1]
    v_pk_add_f32 v[22:23], v[22:23], v[22:23]
    v_cvt_pk_bf16_f32 v70, v20, v21
    v_cvt_pk_bf16_f32 v71, -v22, -v23
    v_pk_mul_f32 v[14:15], v[22:23], v[22:23]
    v_pk_mul_f32 v[18:19], v[20:21], v[22:23]
    v_pk_fma_f32 v[16:17], v[20:21], v[20:21], v[14:15] neg_lo:[0,0,1] neg_hi:[0,0,1]
    v_pk_add_f32 v[18:19], v[18:19], v[18:19]
    v_cvt_pk_bf16_f32 v74, v16, v17
    v_cvt_pk_bf16_f32 v75, -v18, -v19
    v_pk_mul_f32 v[14:15], v[18:19], v[18:19]
    v_pk_mul_f32 v[22:23], v[16:17], v[18:19]
    v_pk_fma_f32 v[20:21], v[16:17], v[16:17], v[14:15] neg_lo:[0,0,1] neg_hi:[0,0,1]
    v_pk_add_f32 v[22:23], v[22:23], v[22:23]
    v_cvt_pk_bf16_f32 v78, v20, v21
    v_cvt_pk_bf16_f32 v79, -v22, -v23
    v_pk_mul_f32 v[14:15], v[22:23], v[22:23]
    v_pk_mul_f32 v[18:19], v[20:21], v[22:23]
    v_pk_fma_f32 v[16:17], v[20:21], v[20:21], v[14:15] neg_lo:[0,0,1] neg_hi:[0,0,1]
    v_pk_add_f32 v[18:19], v[18:19], v[18:19]
    s_nop 0
    v_mul_f32_dpp v24, v50, v16 row_newbcast:14 row_mask:0xf bank_mask:0xf
    v_mul_f32_dpp v26, v50, v18 row_newbcast:14 row_mask:0xf bank_mask:0xf
    s_nop 0
    v_fmac_f32_dpp v24, -v51, v18 row_newbcast:14 row_mask:0xf bank_mask:0xf
    v_fmac_f32_dpp v26, v51, v16 row_newbcast:14 row_mask:0xf bank_mask:0xf
    v_mul_f32_dpp v25, v50, v17 row_newbcast:15 row_mask:0xf bank_mask:0xf
    v_mul_f32_dpp v27, v50, v19 row_newbcast:15 row_mask:0xf bank_mask:0xf
    s_nop 0
    s_nop 0
    v_fmac_f32_dpp v25, -v51, v19 row_newbcast:15 row_mask:0xf bank_mask:0xf
    v_fmac_f32_dpp v27, v51, v17 row_newbcast:15 row_mask:0xf bank_mask:0xf
    v_cvt_pk_bf16_f32 v86, v24, v25
    v_cvt_pk_bf16_f32 v87, v26, v27
    v_pk_mul_f32 v[14:15], v[26:27], v[18:19]
    v_pk_mul_f32 v[30:31], v[26:27], v[16:17]
    v_pk_fma_f32 v[28:29], v[24:25], v[16:17], v[14:15] neg_lo:[0,0,1] neg_hi:[0,0,1]
    v_pk_fma_f32 v[30:31], v[24:25], v[18:19], v[30:31]
    v_cvt_pk_bf16_f32 v90, v28, v29
    v_cvt_pk_bf16_f32 v91, v30, v31
    v_pk_mul_f32 v[14:15], v[18:19], v[18:19]
    v_pk_mul_f32 v[22:23], v[16:17], v[18:19]
    v_pk_fma_f32 v[20:21], v[16:17], v[16:17], v[14:15] neg_lo:[0,0,1] neg_hi:[0,0,1]
    v_pk_add_f32 v[22:23], v[22:23], v[22:23]
    v_pk_mul_f32 v[14:15], v[30:31], v[22:23]
    v_pk_mul_f32 v[26:27], v[30:31], v[20:21]
    v_pk_fma_f32 v[24:25], v[28:29], v[20:21], v[14:15] neg_lo:[0,0,1] neg_hi:[0,0,1]
    v_pk_fma_f32 v[26:27], v[28:29], v[22:23], v[26:27]
    v_cvt_pk_bf16_f32 v94, v24, v25
    v_cvt_pk_bf16_f32 v95, v26, v27
    v_pk_mul_f32 v[14:15], v[22:23], v[22:23]
    v_pk_mul_f32 v[18:19], v[20:21], v[22:23]
    v_pk_fma_f32 v[16:17], v[20:21], v[20:21], v[14:15] neg_lo:[0,0,1] neg_hi:[0,0,1]
    v_pk_add_f32 v[18:19], v[18:19], v[18:19]
    v_cvt_pk_bf16_f32 v82, v16, v17
    v_cvt_pk_bf16_f32 v83, -v18, -v19
    v_pk_mul_f32 v[14:15], v[26:27], v[18:19]
    v_pk_mul_f32 v[30:31], v[26:27], v[16:17]
    v_pk_fma_f32 v[28:29], v[24:25], v[16:17], v[14:15] neg_lo:[0,0,1] neg_hi:[0,0,1]
    v_pk_fma_f32 v[30:31], v[24:25], v[18:19], v[30:31]
    v_cvt_pk_bf16_f32 v98, v28, v29
    v_cvt_pk_bf16_f32 v99, v30, v31
    v_mfma_f32_16x16x32_bf16 v[100:103], v[64:67], v[84:87], v[100:103]
    v_mfma_f32_16x16x32_bf16 v[104:107], v[68:71], v[88:91], v[104:107]
    v_mfma_f32_16x16x32_bf16 v[108:111], v[72:75], v[92:95], v[108:111]
    v_mfma_f32_16x16x32_bf16 v[112:115], v[76:79], v[96:99], v[112:115]
    v_mfma_f32_16x16x32_bf16 v[116:119], v[80:83], v[96:99], v[116:119]
    s_nop 3
    ds_write2_b32 v34, v100, v101 offset0:0 offset1:2
    ds_write2_b32 v34, v102, v103 offset0:4 offset1:6
    s_mov_b32 exec_lo, 0xff00ff00
    s_mov_b32 exec_hi, 0xff00ff00
    ds_write2_b32 v35, v104, v105 offset0:0 offset1:2
    ds_write2_b32 v35, v106, v107 offset0:4 offset1:6
    ds_write2_b32 v36, v108, v109 offset0:0 offset1:2
    ds_write2_b32 v36, v110, v111 offset0:4 offset1:6
    ds_write2_b32 v37, v112, v113 offset0:0 offset1:2
    ds_write2_b32 v37, v114, v115 offset0:4 offset1:6
    s_mov_b64 exec, 0x8000
    ds_write_b32 v39, v118 offset:5760
    s_mov_b64 exec, -1
    s_waitcnt lgkmcnt(0)
    s_barrier
    buffer_load_dword v121, v120, s[44:47], s41 offen sc1
    ds_read_b64 v[128:129], v200
    ds_read_b64 v[130:131], v201
    ds_read_b64 v[132:133], v202
    ds_read_b64 v[134:135], v203
    ds_read_b64 v[136:137], v204
    ds_read_b64 v[138:139], v205
    ds_read_b64 v[140:141], v206
    ds_read_b64 v[142:143], v207
    ds_read_b64 v[144:145], v208
    ds_read_b64 v[146:147], v209
    ds_read_b64 v[148:149], v210
    ds_read_b64 v[150:151], v211
    ds_read_b64 v[152:153], v212
    ds_read_b64 v[154:155], v213
    ds_read_b64 v[156:157], v214
    ds_read_b64 v[158:159], v215
    ds_read_b64 v[160:161], v216
    ds_read_b64 v[162:163], v217
    ds_read_b64 v[164:165], v218
    ds_read_b64 v[166:167], v219
    ds_read_b64 v[168:169], v220
    ds_read_b64 v[170:171], v221
    s_waitcnt lgkmcnt(11)
    v_add_f32 v128, v128, v129
    v_add_f32 v130, v130, v131
    v_add_f32 v132, v132, v133
    v_add_f32 v134, v134, v135
    v_add_f32 v136, v136, v137
    v_add_f32 v138, v138, v139
    v_add_f32 v140, v140, v141
    v_add_f32 v142, v142, v143
    v_add_f32 v144, v144, v145
    v_add_f32 v146, v146, v147
    v_add_f32 v148, v148, v149
    v_cvt_pk_bf16_f32 v64, v134, v136
    v_cvt_pk_bf16_f32 v65, v138, v140
    v_cvt_pk_bf16_f32 v66, v142, v144
    v_cvt_pk_bf16_f32 v67, v146, v148
    ds_write_b128 v40, v[64:67] offset:0
    v_cvt_pk_bf16_f32 v68, v132, v134
    v_cvt_pk_bf16_f32 v69, v136, v138
    v_cvt_pk_bf16_f32 v70, v140, v142
    v_cvt_pk_bf16_f32 v71, v144, v146
    ds_write_b128 v40, v[68:71] offset:4160
    v_cvt_pk_bf16_f32 v72, v130, v132
    v_cvt_pk_bf16_f32 v73, v134, v136
    v_cvt_pk_bf16_f32 v74, v138, v140
    v_cvt_pk_bf16_f32 v75, v142, v144
    ds_write_b128 v40, v[72:75] offset:8320
    v_cvt_pk_bf16_f32 v76, v128, v130
    v_cvt_pk_bf16_f32 v77, v132, v134
    v_cvt_pk_bf16_f32 v78, v136, v138
    v_cvt_pk_bf16_f32 v79, v140, v142
    ds_write_b128 v40, v[76:79] offset:12480
    s_waitcnt lgkmcnt(4)
    v_add_f32 v150, v150, v151
    v_add_f32 v152, v152, v153
    v_add_f32 v154, v154, v155
    v_add_f32 v156, v156, v157
    v_add_f32 v158, v158, v159
    v_add_f32 v160, v160, v161
    v_add_f32 v162, v162, v163
    v_add_f32 v164, v164, v165
    v_add_f32 v166, v166, v167
    v_add_f32 v168, v168, v169
    v_add_f32 v170, v170, v171
    v_cvt_pk_bf16_f32 v80, v156, v158
    v_cvt_pk_bf16_f32 v81, v160, v162
    v_cvt_pk_bf16_f32 v82, v164, v166
    v_cvt_pk_bf16_f32 v83, v168, v170
    ds_write_b128 v40, v[80:83] offset:1024
    v_cvt_pk_bf16_f32 v84, v154, v156
    v_cvt_pk_bf16_f32 v85, v158, v160
    v_cvt_pk_bf16_f32 v86, v162, v164
    v_cvt_pk_bf16_f32 v87, v166, v168
    ds_write_b128 v40, v[84:87] offset:5184
    v_cvt_pk_bf16_f32 v88, v152, v154
    v_cvt_pk_bf16_f32 v89, v156, v158
    v_cvt_pk_bf16_f32 v90, v160, v162
    v_cvt_pk_bf16_f32 v91, v164, v166
    ds_write_b128 v40, v[88:91] offset:9344
    v_cvt_pk_bf16_f32 v92, v150, v152
    v_cvt_pk_bf16_f32 v93, v154, v156
    v_cvt_pk_bf16_f32 v94, v158, v160
    v_cvt_pk_bf16_f32 v95, v162, v164
    ds_write_b128 v40, v[92:95] offset:13504
    s_mov_b32 s70, 262144
    s_waitcnt vmcnt(0)
L_K_p1:
    v_cmp_ne_u32 vcc, v121, v123
    s_cbranch_vccz L_K_p1_ok
    s_sub_u32 s70, s70, 1
    s_cbranch_scc1 L_K_p1_ok
    s_sleep 8
    buffer_load_dword v121, v120, s[44:47], s41 offen sc1
    s_waitcnt vmcnt(0)
    s_branch L_K_p1
L_K_p1_ok:
    s_lshl_b32 s62, s28, 19
    s_lshl_b32 s63, s29, 5
    s_add_u32 s62, s62, s63
    s_add_u32 s62, s62, 0x200000
    s_add_u32 s63, s62, 262144
    buffer_load_dwordx4 v[8:11], v32, s[44:47], s62 offen sc1
    buffer_load_dwordx4 v[12:15], v32, s[44:47], s63 offen sc1
    s_waitcnt lgkmcnt(0)
    s_barrier
    s_cmp_eq_u32 s31, 1
    s_cbranch_scc1 L_conv1
    ds_read_b64 v[128:129], v41 offset:4032
    ds_read_b64 v[130:131], v41 offset:4040
    ds_read_b64 v[160:161], v41 offset:2496
    ds_read_b64 v[162:163], v41 offset:2504
    ds_read_b64 v[192:193], v41 offset:1472
    ds_read_b64 v[194:195], v41 offset:1480
    ds_read_b64 v[224:225], v41 offset:960
    ds_read_b64 v[226:227], v41 offset:968
    ds_read_b64 v[132:133], v41 offset:3968
    ds_read_b64 v[134:135], v41 offset:3976
    ds_read_b64 v[164:165], v41 offset:2432
    ds_read_b64 v[166:167], v41 offset:2440
    ds_read_b64 v[196:197], v41 offset:1408
    ds_read_b64 v[198:199], v41 offset:1416
    ds_read_b64 v[228:229], v41 offset:896
    ds_read_b64 v[230:231], v41 offset:904
    ds_read_b64 v[136:137], v41 offset:3904
    ds_read_b64 v[138:139], v41 offset:3912
    ds_read_b64 v[168:169], v41 offset:2368
    ds_read_b64 v[170:171], v41 offset:2376
    ds_read_b64 v[200:201], v41 offset:1344
    ds_read_b64 v[202:203], v41 offset:1352
    ds_read_b64 v[232:233], v41 offset:832
    ds_read_b64 v[234:235], v41 offset:840
    ds_read_b64 v[140:141], v41 offset:3840
    ds_read_b64 v[142:143], v41 offset:3848
    ds_read_b64 v[172:173], v41 offset:2304
    ds_read_b64 v[174:175], v41 offset:2312
    ds_read_b64 v[204:205], v41 offset:1280
    ds_read_b64 v[206:207], v41 offset:1288
    ds_read_b64 v[236:237], v41 offset:768
    ds_read_b64 v[238:239], v41 offset:776
    ds_read_b64 v[144:145], v41 offset:3776
    ds_read_b64 v[146:147], v41 offset:3784
    ds_read_b64 v[176:177], v41 offset:2240
    ds_read_b64 v[178:179], v41 offset:2248
    ds_read_b64 v[208:209], v41 offset:1216
    ds_read_b64 v[210:211], v41 offset:1224
    ds_read_b64 v[240:241], v41 offset:704
    ds_read_b64 v[242:243], v41 offset:712
    ds_read_b64 v[148:149], v41 offset:3712
    ds_read_b64 v[150:151], v41 offset:3720
    ds_read_b64 v[180:181], v41 offset:2176
    ds_read_b64 v[182:183], v41 offset:2184
    ds_read_b64 v[212:213], v41 offset:1152
    ds_read_b64 v[214:215], v41 offset:1160
    ds_read_b64 v[244:245], v41 offset:640
    ds_read_b64 v[246:247], v41 offset:648
    ds_read_b64 v[152:153], v41 offset:3648
    ds_read_b64 v[154:155], v41 offset:3656
    ds_read_b64 v[184:185], v41 offset:2112
    ds_read_b64 v[186:187], v41 offset:2120
    ds_read_b64 v[216:217], v41 offset:1088
    ds_read_b64 v[218:219], v41 offset:1096
    ds_read_b64 v[248:249], v41 offset:576
    ds_read_b64 v[250:251], v41 offset:584
    ds_read_b64 v[156:157], v41 offset:3584
    ds_read_b64 v[158:159], v41 offset:3592
    ds_read_b64 v[188:189], v41 offset:2048
    ds_read_b64 v[190:191], v41 offset:2056
    ds_read_b64 v[220:221], v41 offset:1024
    ds_read_b64 v[222:223], v41 offset:1032
    ds_read_b64 v[252:253], v41 offset:512
    ds_read_b64 v[254:255], v41 offset:520
    s_waitcnt vmcnt(0)
    ds_write_b128 v33, v[8:11]
    ds_write_b128 v33, v[12:15] offset:512
    s_waitcnt lgkmcnt(0)
    s_barrier
    s_setprio 2
    s_lshl_b32 s41, s30, 13
    s_add_u32 s41, s41, 54272
    v_add_u32 v45, s41, v7
    s_lshl_b32 s42, s36, 16
    s_and_b32 s43, s36, 0xffff0000
    s_cmp_eq_u32 s30, 0
    s_cselect_b32 s42, s42, s43
    s_lshl_b32 s48, s32, 12
    s_add_u32 s48, s48, 0xa00800
    v_add_u32 v44, 2048, v44
    ds_read_b64 v[16:17], v44 offset:0
    ds_read_b64 v[18:19], v44 offset:512
    ds_read_b64 v[20:21], v44 offset:1024
    ds_read_b64 v[22:23], v44 offset:1536
    ds_read_b128 v[96:99], v42 offset:448
    ds_read_b128 v[100:103], v42 offset:384
    ds_read_b128 v[104:107], v42 offset:320
    ds_read_b128 v[108:111], v42 offset:256
    ds_read_b128 v[112:115], v42 offset:192
    ds_read_b128 v[116:119], v42 offset:128
    ds_read_b128 v[120:123], v42 offset:64
    s_waitcnt lgkmcnt(6)
    v_mfma_f32_16x16x32_bf16 v[64:67], v[128:131], v[96:99], 0
    v_mfma_f32_16x16x32_bf16 v[76:79], v[160:163], v[96:99], 0
    v_mfma_f32_16x16x32_bf16 v[84:87], v[192:195], v[96:99], 0
    v_mfma_f32_16x16x32_bf16 v[88:91], v[224:227], v[96:99], 0
    ds_read_b128 v[124:127], v42 offset:0
    s_waitcnt lgkmcnt(6)
    v_mfma_f32_16x16x32_bf16 v[64:67], v[132:135], v[100:103], v[64:67]
    v_mfma_f32_16x16x32_bf16 v[76:79], v[164:167], v[100:103], v[76:79]
    v_mfma_f32_16x16x32_bf16 v[84:87], v[196:199], v[100:103], v[84:87]
    v_mfma_f32_16x16x32_bf16 v[88:91], v[228:231], v[100:103], v[88:91]
    ds_read_b128 v[96:99], v42 offset:960
    s_waitcnt lgkmcnt(6)
    v_mfma_f32_16x16x32_bf16 v[64:67], v[136:139], v[104:107], v[64:67]
    v_mfma_f32_16x16x32_bf16 v[76:79], v[168:171], v[104:107], v[76:79]
    v_mfma_f32_16x16x32_bf16 v[84:87], v[200:203], v[104:107], v[84:87]
    v_mfma_f32_16x16x32_bf16 v[88:91], v[232:235], v[104:107], v[88:91]
    ds_read_b128 v[100:103], v42 offset:896
    s_waitcnt lgkmcnt(6)
    v_mfma_f32_16x16x32_bf16 v[64:67], v[140:143], v[108:111], v[64:67]
    v_mfma_f32_16x16x32_bf16 v[76:79], v[172:175], v[108:111], v[76:79]
    v_mfma_f32_16x16x32_bf16 v[84:87], v[204:207], v[108:111], v[84:87]
    v_mfma_f32_16x16x32_bf16 v[88:91], v[236:239], v[108:111], v[88:91]
    ds_read_b128 v[104:107], v42 offset:832
    s_waitcnt lgkmcnt(6)
    v_mfma_f32_16x16x32_bf16 v[64:67], v[144:147], v[112:115], v[64:67]
    v_mfma_f32_16x16x32_bf16 v[76:79], v[176:179], v[112:115], v[76:79]
    v_mfma_f32_16x16x32_bf16 v[84:87], v[208:211], v[112:115], v[84:87]
    v_mfma_f32_16x16x32_bf16 v[88:91], v[240:243], v[112:115], v[88:91]
    ds_read_b128 v[108:111], v42 offset:768
    s_waitcnt lgkmcnt(6)
    v_mfma_f32_16x16x32_bf16 v[64:67], v[148:151], v[116:119], v[64:67]
    v_mfma_f32_16x16x32_bf16 v[76:79], v[180:183], v[116:119], v[76:79]
    v_mfma_f32_16x16x32_bf16 v[84:87], v[212:215], v[116:119], v[84:87]
    v_mfma_f32_16x16x32_bf16 v[88:91], v[244:247], v[116:119], v[88:91]
    ds_read_b128 v[112:115], v42 offset:704
    s_waitcnt lgkmcnt(6)
    v_mfma_f32_16x16x32_bf16 v[64:67], v[152:155], v[120:123], v[64:67]
    v_mfma_f32_16x16x32_bf16 v[76:79], v[184:187], v[120:123], v[76:79]
    v_mfma_f32_16x16x32_bf16 v[84:87], v[216:219], v[120:123], v[84:87]
    v_mfma_f32_16x16x32_bf16 v[88:91], v[248:251], v[120:123], v[88:91]
    ds_read_b128 v[116:119], v42 offset:640
    s_waitcnt lgkmcnt(6)
    v_mfma_f32_16x16x32_bf16 v[64:67], v[156:159], v[124:127], v[64:67]
    v_mfma_f32_16x16x32_bf16 v[76:79], v[188:191], v[124:127], v[76:79]
    v_mfma_f32_16x16x32_bf16 v[84:87], v[220:223], v[124:127], v[84:87]
    v_mfma_f32_16x16x32_bf16 v[88:91], v[252:255], v[124:127], v[88:91]
    ds_read_b128 v[120:123], v42 offset:576
    s_waitcnt lgkmcnt(6)
    v_mfma_f32_16x16x32_bf16 v[68:71], v[128:131], v[96:99], 0
    v_mfma_f32_16x16x32_bf16 v[80:83], v[160:163], v[96:99], 0
    v_mfma_f32_16x16x32_bf16 v[88:91], v[192:195], v[96:99], v[88:91]
    v_mfma_f32_16x16x32_bf16 v[92:95], v[224:227], v[96:99], 0
    ds_read_b128 v[124:127], v42 offset:512
    s_waitcnt lgkmcnt(6)
    v_mfma_f32_16x16x32_bf16 v[68:71], v[132:135], v[100:103], v[68:71]
    v_mfma_f32_16x16x32_bf16 v[80:83], v[164:167], v[100:103], v[80:83]
    v_mfma_f32_16x16x32_bf16 v[88:91], v[196:199], v[100:103], v[88:91]
    v_mfma_f32_16x16x32_bf16 v[92:95], v[228:231], v[100:103], v[92:95]
    ds_read_b128 v[96:99], v42 offset:1472
    s_waitcnt lgkmcnt(6)
    v_mfma_f32_16x16x32_bf16 v[68:71], v[136:139], v[104:107], v[68:71]
    v_mfma_f32_16x16x32_bf16 v[80:83], v[168:171], v[104:107], v[80:83]
    v_mfma_f32_16x16x32_bf16 v[88:91], v[200:203], v[104:107], v[88:91]
    v_mfma_f32_16x16x32_bf16 v[92:95], v[232:235], v[104:107], v[92:95]
    ds_read_b128 v[100:103], v42 offset:1408
    s_waitcnt lgkmcnt(6)
    v_mfma_f32_16x16x32_bf16 v[68:71], v[140:143], v[108:111], v[68:71]
    v_mfma_f32_16x16x32_bf16 v[80:83], v[172:175], v[108:111], v[80:83]
    v_mfma_f32_16x16x32_bf16 v[88:91], v[204:207], v[108:111], v[88:91]
    v_mfma_f32_16x16x32_bf16 v[92:95], v[236:239], v[108:111], v[92:95]
    ds_read_b128 v[104:107], v42 offset:1344
    s_waitcnt lgkmcnt(6)
    v_mfma_f32_16x16x32_bf16 v[68:71], v[144:147], v[112:115], v[68:71]
    v_mfma_f32_16x16x32_bf16 v[80:83], v[176:179], v[112:115], v[80:83]
    v_mfma_f32_16x16x32_bf16 v[88:91], v[208:211], v[112:115], v[88:91]
    v_mfma_f32_16x16x32_bf16 v[92:95], v[240:243], v[112:115], v[92:95]
    ds_read_b128 v[108:111], v42 offset:1280
    s_waitcnt lgkmcnt(6)
    v_mfma_f32_16x16x32_bf16 v[68:71], v[148:151], v[116:119], v[68:71]
    v_mfma_f32_16x16x32_bf16 v[80:83], v[180:183], v[116:119], v[80:83]
    v_mfma_f32_16x16x32_bf16 v[88:91], v[212:215], v[116:119], v[88:91]
    v_mfma_f32_16x16x32_bf16 v[92:95], v[244:247], v[116:119], v[92:95]
    ds_read_b128 v[112:115], v42 offset:1216
    s_waitcnt lgkmcnt(6)
    v_mfma_f32_16x16x32_bf16 v[68:71], v[152:155], v[120:123], v[68:71]
    v_mfma_f32_16x16x32_bf16 v[80:83], v[184:187], v[120:123], v[80:83]
    v_mfma_f32_16x16x32_bf16 v[88:91], v[216:219], v[120:123], v[88:91]
    v_mfma_f32_16x16x32_bf16 v[92:95], v[248:251], v[120:123], v[92:95]
    ds_read_b128 v[116:119], v42 offset:1152
    s_waitcnt lgkmcnt(6)
    v_mfma_f32_16x16x32_bf16 v[68:71], v[156:159], v[124:127], v[68:71]
    v_mfma_f32_16x16x32_bf16 v[80:83], v[188:191], v[124:127], v[80:83]
    v_mfma_f32_16x16x32_bf16 v[88:91], v[220:223], v[124:127], v[88:91]
    v_mfma_f32_16x16x32_bf16 v[92:95], v[252:255], v[124:127], v[92:95]
    ds_read_b128 v[120:123], v42 offset:1088
    s_waitcnt lgkmcnt(6)
    v_mfma_f32_16x16x32_bf16 v[72:75], v[128:131], v[96:99], 0
    v_mfma_f32_16x16x32_bf16 v[84:87], v[160:163], v[96:99], v[84:87]
    v_mfma_f32_16x16x32_bf16 v[92:95], v[192:195], v[96:99], v[92:95]
    ds_read_b128 v[124:127], v42 offset:1024
    s_waitcnt lgkmcnt(6)
    v_mfma_f32_16x16x32_bf16 v[72:75], v[132:135], v[100:103], v[72:75]
    v_mfma_f32_16x16x32_bf16 v[84:87], v[164:167], v[100:103], v[84:87]
    v_mfma_f32_16x16x32_bf16 v[92:95], v[196:199], v[100:103], v[92:95]
    ds_read_b128 v[96:99], v42 offset:1984
    s_waitcnt lgkmcnt(6)
    v_mfma_f32_16x16x32_bf16 v[72:75], v[136:139], v[104:107], v[72:75]
    v_mfma_f32_16x16x32_bf16 v[84:87], v[168:171], v[104:107], v[84:87]
    v_mfma_f32_16x16x32_bf16 v[92:95], v[200:203], v[104:107], v[92:95]
    ds_read_b128 v[100:103], v42 offset:1920
    s_waitcnt lgkmcnt(6)
    v_mfma_f32_16x16x32_bf16 v[72:75], v[140:143], v[108:111], v[72:75]
    v_mfma_f32_16x16x32_bf16 v[84:87], v[172:175], v[108:111], v[84:87]
    v_mfma_f32_16x16x32_bf16 v[92:95], v[204:207], v[108:111], v[92:95]
    ds_read_b128 v[104:107], v42 offset:1856
    s_waitcnt lgkmcnt(6)
    v_mfma_f32_16x16x32_bf16 v[72:75], v[144:147], v[112:115], v[72:75]
    v_mfma_f32_16x16x32_bf16 v[84:87], v[176:179], v[112:115], v[84:87]
    v_mfma_f32_16x16x32_bf16 v[92:95], v[208:211], v[112:115], v[92:95]
    ds_read_b128 v[108:111], v42 offset:1792
    s_waitcnt lgkmcnt(6)
    v_mfma_f32_16x16x32_bf16 v[72:75], v[148:151], v[116:119], v[72:75]
    v_mfma_f32_16x16x32_bf16 v[84:87], v[180:183], v[116:119], v[84:87]
    v_mfma_f32_16x16x32_bf16 v[92:95], v[212:215], v[116:119], v[92:95]
    ds_read_b128 v[112:115], v42 offset:1728
    s_waitcnt lgkmcnt(6)
    v_mfma_f32_16x16x32_bf16 v[72:75], v[152:155], v[120:123], v[72:75]
    v_mfma_f32_16x16x32_bf16 v[84:87], v[184:187], v[120:123], v[84:87]
    v_mfma_f32_16x16x32_bf16 v[92:95], v[216:219], v[120:123], v[92:95]
    ds_read_b128 v[116:119], v42 offset:1664
    s_waitcnt lgkmcnt(6)
    v_mfma_f32_16x16x32_bf16 v[72:75], v[156:159], v[124:127], v[72:75]
    v_mfma_f32_16x16x32_bf16 v[84:87], v[188:191], v[124:127], v[84:87]
    v_mfma_f32_16x16x32_bf16 v[92:95], v[220:223], v[124:127], v[92:95]
    ds_read_b128 v[120:123], v42 offset:1600
    s_waitcnt lgkmcnt(6)
    v_mfma_f32_16x16x32_bf16 v[76:79], v[128:131], v[96:99], v[76:79]
    v_mfma_f32_16x16x32_bf16 v[88:91], v[160:163], v[96:99], v[88:91]
    ds_read_b128 v[124:127], v42 offset:1536
    s_waitcnt lgkmcnt(6)
    v_mfma_f32_16x16x32_bf16 v[76:79], v[132:135], v[100:103], v[76:79]
    v_mfma_f32_16x16x32_bf16 v[88:91], v[164:167], v[100:103], v[88:91]
    ds_read_b128 v[96:99], v42 offset:2496
    s_waitcnt lgkmcnt(6)
    v_mfma_f32_16x16x32_bf16 v[76:79], v[136:139], v[104:107], v[76:79]
    v_mfma_f32_16x16x32_bf16 v[88:91], v[168:171], v[104:107], v[88:91]
    ds_read_b128 v[100:103], v42 offset:2432
    s_waitcnt lgkmcnt(6)
    v_mfma_f32_16x16x32_bf16 v[76:79], v[140:143], v[108:111], v[76:79]
    v_mfma_f32_16x16x32_bf16 v[88:91], v[172:175], v[108:111], v[88:91]
    ds_read_b128 v[104:107], v42 offset:2368
    s_waitcnt lgkmcnt(6)
    v_mfma_f32_16x16x32_bf16 v[76:79], v[144:147], v[112:115], v[76:79]
    v_mfma_f32_16x16x32_bf16 v[88:91], v[176:179], v[112:115], v[88:91]
    ds_read_b128 v[108:111], v42 offset:2304
    s_waitcnt lgkmcnt(6)
    v_mfma_f32_16x16x32_bf16 v[76:79], v[148:151], v[116:119], v[76:79]
    v_mfma_f32_16x16x32_bf16 v[88:91], v[180:183], v[116:119], v[88:91]
    ds_read_b128 v[112:115], v42 offset:2240
    s_waitcnt lgkmcnt(6)
    v_mfma_f32_16x16x32_bf16 v[76:79], v[152:155], v[120:123], v[76:79]
    v_mfma_f32_16x16x32_bf16 v[88:91], v[184:187], v[120:123], v[88:91]
    ds_read_b128 v[116:119], v42 offset:2176
    s_waitcnt lgkmcnt(6)
    v_mfma_f32_16x16x32_bf16 v[76:79], v[156:159], v[124:127], v[76:79]
    v_mfma_f32_16x16x32_bf16 v[88:91], v[188:191], v[124:127], v[88:91]
    ds_read_b128 v[120:123], v42 offset:2112
    ds_write_b128 v45, v[64:67] offset:0
    ds_write_b128 v45, v[68:71] offset:1024
    ds_write_b128 v45, v[72:75] offset:2048
    s_nop 2
    ds_write_b128 v45, v[76:79] offset:3072
    s_waitcnt lgkmcnt(0)
    s_barrier
    s_waitcnt lgkmcnt(10)
    v_mfma_f32_16x16x32_bf16 v[80:83], v[128:131], v[96:99], v[80:83]
    v_mfma_f32_16x16x32_bf16 v[92:95], v[160:163], v[96:99], v[92:95]
    ds_read_b128 v[124:127], v42 offset:2048
    s_waitcnt lgkmcnt(10)
    v_mfma_f32_16x16x32_bf16 v[80:83], v[132:135], v[100:103], v[80:83]
    v_mfma_f32_16x16x32_bf16 v[92:95], v[164:167], v[100:103], v[92:95]
    ds_read_b128 v[96:99], v42 offset:3008
    s_waitcnt lgkmcnt(10)
    v_mfma_f32_16x16x32_bf16 v[80:83], v[136:139], v[104:107], v[80:83]
    v_mfma_f32_16x16x32_bf16 v[92:95], v[168:171], v[104:107], v[92:95]
    ds_read_b128 v[100:103], v42 offset:2944
    s_waitcnt lgkmcnt(10)
    v_mfma_f32_16x16x32_bf16 v[80:83], v[140:143], v[108:111], v[80:83]
    v_mfma_f32_16x16x32_bf16 v[92:95], v[172:175], v[108:111], v[92:95]
    ds_read_b128 v[104:107], v42 offset:2880
    s_waitcnt lgkmcnt(10)
    v_mfma_f32_16x16x32_bf16 v[80:83], v[144:147], v[112:115], v[80:83]
    v_mfma_f32_16x16x32_bf16 v[92:95], v[176:179], v[112:115], v[92:95]
    ds_read_b128 v[108:111], v42 offset:2816
    s_waitcnt lgkmcnt(10)
    v_mfma_f32_16x16x32_bf16 v[80:83], v[148:151], v[116:119], v[80:83]
    v_mfma_f32_16x16x32_bf16 v[92:95], v[180:183], v[116:119], v[92:95]
    ds_read_b128 v[112:115], v42 offset:2752
    s_waitcnt lgkmcnt(10)
    v_mfma_f32_16x16x32_bf16 v[80:83], v[152:155], v[120:123], v[80:83]
    v_mfma_f32_16x16x32_bf16 v[92:95], v[184:187], v[120:123], v[92:95]
    ds_read_b128 v[116:119], v42 offset:2688
    s_waitcnt lgkmcnt(6)
    v_mfma_f32_16x16x32_bf16 v[80:83], v[156:159], v[124:127], v[80:83]
    v_mfma_f32_16x16x32_bf16 v[92:95], v[188:191], v[124:127], v[92:95]
    ds_read_b128 v[120:123], v42 offset:2624
    s_waitcnt lgkmcnt(6)
    v_mfma_f32_16x16x32_bf16 v[84:87], v[128:131], v[96:99], v[84:87]
    ds_read_b128 v[124:127], v42 offset:2560
    s_waitcnt lgkmcnt(6)
    v_mfma_f32_16x16x32_bf16 v[84:87], v[132:135], v[100:103], v[84:87]
    ds_read_b128 v[96:99], v42 offset:3520
    s_waitcnt lgkmcnt(6)
    v_mfma_f32_16x16x32_bf16 v[84:87], v[136:139], v[104:107], v[84:87]
    ds_read_b128 v[100:103], v42 offset:3456
    s_waitcnt lgkmcnt(6)
    v_mfma_f32_16x16x32_bf16 v[84:87], v[140:143], v[108:111], v[84:87]
    ds_read_b128 v[104:107], v42 offset:3392
    s_waitcnt lgkmcnt(6)
    v_mfma_f32_16x16x32_bf16 v[84:87], v[144:147], v[112:115], v[84:87]
    ds_read_b128 v[108:111], v42 offset:3328
    s_waitcnt lgkmcnt(6)
    v_mfma_f32_16x16x32_bf16 v[84:87], v[148:151], v[116:119], v[84:87]
    ds_read_b128 v[112:115], v42 offset:3264
    s_waitcnt lgkmcnt(6)
    v_mfma_f32_16x16x32_bf16 v[84:87], v[152:155], v[120:123], v[84:87]
    ds_read_b128 v[116:119], v42 offset:3200
    s_waitcnt lgkmcnt(6)
    v_mfma_f32_16x16x32_bf16 v[84:87], v[156:159], v[124:127], v[84:87]
    ds_read_b128 v[120:123], v42 offset:3136
    s_waitcnt lgkmcnt(6)
    v_mfma_f32_16x16x32_bf16 v[88:91], v[128:131], v[96:99], v[88:91]
    ds_read_b128 v[124:127], v42 offset:3072
    s_waitcnt lgkmcnt(6)
    v_mfma_f32_16x16x32_bf16 v[88:91], v[132:135], v[100:103], v[88:91]
    ds_read_b128 v[96:99], v42 offset:4032
    s_waitcnt lgkmcnt(6)
    v_mfma_f32_16x16x32_bf16 v[88:91], v[136:139], v[104:107], v[88:91]
    ds_read_b128 v[100:103], v42 offset:3968
    s_waitcnt lgkmcnt(6)
    v_mfma_f32_16x16x32_bf16 v[88:91], v[140:143], v[108:111], v[88:91]
    ds_read_b128 v[104:107], v42 offset:3904
    s_waitcnt lgkmcnt(6)
    v_mfma_f32_16x16x32_bf16 v[88:91], v[144:147], v[112:115], v[88:91]
    ds_read_b128 v[108:111], v42 offset:3840
    s_waitcnt lgkmcnt(6)
    v_mfma_f32_16x16x32_bf16 v[88:91], v[148:151], v[116:119], v[88:91]
    ds_read_b128 v[112:115], v42 offset:3776
    s_waitcnt lgkmcnt(6)
    v_mfma_f32_16x16x32_bf16 v[88:91], v[152:155], v[120:123], v[88:91]
    ds_read_b128 v[116:119], v42 offset:3712
    s_waitcnt lgkmcnt(6)
    v_mfma_f32_16x16x32_bf16 v[88:91], v[156:159], v[124:127], v[88:91]
    ds_read_b128 v[120:123], v42 offset:3648
    s_barrier
    ds_read_b128 v[48:51], v45 offset:4096
    ds_read_b128 v[52:55], v45 offset:5120
    ds_read_b128 v[56:59], v45 offset:6144
    ds_read_b128 v[60:63], v45 offset:7168
    s_waitcnt lgkmcnt(10)
    v_mfma_f32_16x16x32_bf16 v[92:95], v[128:131], v[96:99], v[92:95]
    ds_read_b128 v[124:127], v42 offset:3584
    s_waitcnt lgkmcnt(10)
    v_mfma_f32_16x16x32_bf16 v[92:95], v[132:135], v[100:103], v[92:95]
    s_waitcnt lgkmcnt(9)
    v_mfma_f32_16x16x32_bf16 v[92:95], v[136:139], v[104:107], v[92:95]
    s_waitcnt lgkmcnt(1)
    s_waitcnt lgkmcnt(8)
    v_mfma_f32_16x16x32_bf16 v[92:95], v[140:143], v[108:111], v[92:95]
    v_lshlrev_b32 v24, 16, v16
    v_and_b32 v25, s59, v16
    v_lshlrev_b32 v26, 16, v17
    v_and_b32 v27, s59, v17
    v_fmac_f32 v48, s42, v24
    v_fmac_f32 v49, s42, v25
    v_fmac_f32 v50, s42, v26
    v_fmac_f32 v51, s42, v27
    v_add_f32 v48, v48, v80
    s_waitcnt lgkmcnt(7)
    v_mfma_f32_16x16x32_bf16 v[92:95], v[144:147], v[112:115], v[92:95]
    v_add_f32 v49, v49, v81
    v_add_f32 v50, v50, v82
    v_add_f32_e64 v51, v51, v83
    v_cvt_pk_bf16_f32 v48, v48, v49
    v_cvt_pk_bf16_f32 v49, v50, v51
    buffer_store_dwordx2 v[48:49], v43, s[44:47], s48 offen offset:0 sc1
    v_lshlrev_b32 v28, 16, v18
    v_and_b32 v29, s59, v18
    v_lshlrev_b32 v30, 16, v19
    s_waitcnt lgkmcnt(6)
    v_mfma_f32_16x16x32_bf16 v[92:95], v[148:151], v[116:119], v[92:95]
    v_and_b32 v31, s59, v19
    v_fmac_f32 v52, s42, v28
    v_fmac_f32 v53, s42, v29
    v_fmac_f32 v54, s42, v30
    v_fmac_f32 v55, s42, v31
    v_add_f32 v52, v52, v84
    v_add_f32 v53, v53, v85
    v_add_f32 v54, v54, v86
    v_add_f32 v55, v55, v87
    s_waitcnt lgkmcnt(5)
    v_mfma_f32_16x16x32_bf16 v[92:95], v[152:155], v[120:123], v[92:95]
    v_cvt_pk_bf16_f32 v52, v52, v53
    v_cvt_pk_bf16_f32 v53, v54, v55
    buffer_store_dwordx2 v[52:53], v43, s[44:47], s48 offen offset:512 sc1
    v_lshlrev_b32 v24, 16, v20
    v_and_b32 v25, s59, v20
    v_lshlrev_b32 v26, 16, v21
    v_and_b32 v27, s59, v21
    v_fmac_f32 v56, s42, v24
    v_fmac_f32_e64 v57, s42, v25
    s_waitcnt lgkmcnt(0)
    v_mfma_f32_16x16x32_bf16 v[92:95], v[156:159], v[124:127], v[92:95]
    v_fmac_f32 v58, s42, v26
    v_fmac_f32 v59, s42, v27
    v_add_f32 v56, v56, v88
    v_add_f32 v57, v57, v89
    v_add_f32 v58, v58, v90
    v_add_f32 v59, v59, v91
    v_cvt_pk_bf16_f32 v56, v56, v57
    v_cvt_pk_bf16_f32 v57, v58, v59
    buffer_store_dwordx2 v[56:57], v43, s[44:47], s48 offen offset:1024 sc1
    v_lshlrev_b32 v28, 16, v22
    v_and_b32 v29, s59, v22
    v_lshlrev_b32 v30, 16, v23
    v_and_b32 v31, s59, v23
    v_fmac_f32 v60, s42, v28
    v_fmac_f32 v61, s42, v29
    v_fmac_f32 v62, s42, v30
    v_fmac_f32 v63, s42, v31
    v_add_f32 v60, v60, v92
    v_add_f32 v61, v61, v93
    v_add_f32 v62, v62, v94
    v_add_f32 v63, v63, v95
    v_cvt_pk_bf16_f32 v60, v60, v61
    v_cvt_pk_bf16_f32 v61, v62, v63
    buffer_store_dwordx2 v[60:61], v43, s[44:47], s48 offen offset:1536 sc1
    s_branch L_K_pub
L_conv1:
    ds_read_b64 v[128:129], v41 offset:3520
    ds_read_b64 v[130:131], v41 offset:3528
    ds_read_b64 v[160:161], v41 offset:3008
    ds_read_b64 v[162:163], v41 offset:3016
    ds_read_b64 v[192:193], v41 offset:1984
    ds_read_b64 v[194:195], v41 offset:1992
    ds_read_b64 v[224:225], v41 offset:448
    ds_read_b64 v[226:227], v41 offset:456
    ds_read_b64 v[132:133], v41 offset:3456
    ds_read_b64 v[134:135], v41 offset:3464
    ds_read_b64 v[164:165], v41 offset:2944
    ds_read_b64 v[166:167], v41 offset:2952
    ds_read_b64 v[196:197], v41 offset:1920
    ds_read_b64 v[198:199], v41 offset:1928
    ds_read_b64 v[228:229], v41 offset:384
    ds_read_b64 v[230:231], v41 offset:392
    ds_read_b64 v[136:137], v41 offset:3392
    ds_read_b64 v[138:139], v41 offset:3400
    ds_read_b64 v[168:169], v41 offset:2880
    ds_read_b64 v[170:171], v41 offset:2888
    ds_read_b64 v[200:201], v41 offset:1856
    ds_read_b64 v[202:203], v41 offset:1864
    ds_read_b64 v[232:233], v41 offset:320
    ds_read_b64 v[234:235], v41 offset:328
    ds_read_b64 v[140:141], v41 offset:3328
    ds_read_b64 v[142:143], v41 offset:3336
    ds_read_b64 v[172:173], v41 offset:2816
    ds_read_b64 v[174:175], v41 offset:2824
    ds_read_b64 v[204:205], v41 offset:1792
    ds_read_b64 v[206:207], v41 offset:1800
    ds_read_b64 v[236:237], v41 offset:256
    ds_read_b64 v[238:239], v41 offset:264
    ds_read_b64 v[144:145], v41 offset:3264
    ds_read_b64 v[146:147], v41 offset:3272
    ds_read_b64 v[176:177], v41 offset:2752
    ds_read_b64 v[178:179], v41 offset:2760
    ds_read_b64 v[208:209], v41 offset:1728
    ds_read_b64 v[210:211], v41 offset:1736
    ds_read_b64 v[240:241], v41 offset:192
    ds_read_b64 v[242:243], v41 offset:200
    ds_read_b64 v[148:149], v41 offset:3200
    ds_read_b64 v[150:151], v41 offset:3208
    ds_read_b64 v[180:181], v41 offset:2688
    ds_read_b64 v[182:183], v41 offset:2696
    ds_read_b64 v[212:213], v41 offset:1664
    ds_read_b64 v[214:215], v41 offset:1672
    ds_read_b64 v[244:245], v41 offset:128
    ds_read_b64 v[246:247], v41 offset:136
    ds_read_b64 v[152:153], v41 offset:3136
    ds_read_b64 v[154:155], v41 offset:3144
    ds_read_b64 v[184:185], v41 offset:2624
    ds_read_b64 v[186:187], v41 offset:2632
    ds_read_b64 v[216:217], v41 offset:1600
    ds_read_b64 v[218:219], v41 offset:1608
    ds_read_b64 v[248:249], v41 offset:64
    ds_read_b64 v[250:251], v41 offset:72
    ds_read_b64 v[156:157], v41 offset:3072
    ds_read_b64 v[158:159], v41 offset:3080
    ds_read_b64 v[188:189], v41 offset:2560
    ds_read_b64 v[190:191], v41 offset:2568
    ds_read_b64 v[220:221], v41 offset:1536
    ds_read_b64 v[222:223], v41 offset:1544
    ds_read_b64 v[252:253], v41 offset:0
    ds_read_b64 v[254:255], v41 offset:8
    s_waitcnt vmcnt(0)
    ds_write_b128 v33, v[8:11]
    ds_write_b128 v33, v[12:15] offset:512
    s_waitcnt lgkmcnt(0)
    s_barrier
    s_setprio 2
    s_lshl_b32 s41, s30, 13
    s_add_u32 s41, s41, 54272
    v_add_u32 v45, s41, v7
    s_lshl_b32 s42, s36, 16
    s_and_b32 s43, s36, 0xffff0000
    s_cmp_eq_u32 s30, 0
    s_cselect_b32 s42, s42, s43
    s_lshl_b32 s48, s32, 12
    s_add_u32 s48, s48, 0xa00000
    v_subrev_u32 v44, 2048, v44
    ds_read_b64 v[16:17], v44 offset:0
    ds_read_b64 v[18:19], v44 offset:512
    ds_read_b64 v[20:21], v44 offset:1024
    ds_read_b64 v[22:23], v44 offset:1536
    ds_read_b128 v[96:99], v42 offset:448
    ds_read_b128 v[100:103], v42 offset:384
    ds_read_b128 v[104:107], v42 offset:320
    ds_read_b128 v[108:111], v42 offset:256
    ds_read_b128 v[112:115], v42 offset:192
    ds_read_b128 v[116:119], v42 offset:128
    ds_read_b128 v[120:123], v42 offset:64
    s_waitcnt lgkmcnt(6)
    v_mfma_f32_16x16x32_bf16 v[68:71], v[128:131], v[96:99], 0
    v_mfma_f32_16x16x32_bf16 v[72:75], v[160:163], v[96:99], 0
    v_mfma_f32_16x16x32_bf16 v[80:83], v[192:195], v[96:99], 0
    v_mfma_f32_16x16x32_bf16 v[92:95], v[224:227], v[96:99], 0
    ds_read_b128 v[124:127], v42 offset:0
    s_waitcnt lgkmcnt(6)
    v_mfma_f32_16x16x32_bf16 v[68:71], v[132:135], v[100:103], v[68:71]
    v_mfma_f32_16x16x32_bf16 v[72:75], v[164:167], v[100:103], v[72:75]
    v_mfma_f32_16x16x32_bf16 v[80:83], v[196:199], v[100:103], v[80:83]
    v_mfma_f32_16x16x32_bf16 v[92:95], v[228:231], v[100:103], v[92:95]
    ds_read_b128 v[96:99], v42 offset:960
    s_waitcnt lgkmcnt(6)
    v_mfma_f32_16x16x32_bf16 v[68:71], v[136:139], v[104:107], v[68:71]
    v_mfma_f32_16x16x32_bf16 v[72:75], v[168:171], v[104:107], v[72:75]
    v_mfma_f32_16x16x32_bf16 v[80:83], v[200:203], v[104:107], v[80:83]
    v_mfma_f32_16x16x32_bf16 v[92:95], v[232:235], v[104:107], v[92:95]
    ds_read_b128 v[100:103], v42 offset:896
    s_waitcnt lgkmcnt(6)
    v_mfma_f32_16x16x32_bf16 v[68:71], v[140:143], v[108:111], v[68:71]
    v_mfma_f32_16x16x32_bf16 v[72:75], v[172:175], v[108:111], v[72:75]
    v_mfma_f32_16x16x32_bf16 v[80:83], v[204:207], v[108:111], v[80:83]
    v_mfma_f32_16x16x32_bf16 v[92:95], v[236:239], v[108:111], v[92:95]
    ds_read_b128 v[104:107], v42 offset:832
    s_waitcnt lgkmcnt(6)
    v_mfma_f32_16x16x32_bf16 v[68:71], v[144:147], v[112:115], v[68:71]
    v_mfma_f32_16x16x32_bf16 v[72:75], v[176:179], v[112:115], v[72:75]
    v_mfma_f32_16x16x32_bf16 v[80:83], v[208:211], v[112:115], v[80:83]
    v_mfma_f32_16x16x32_bf16 v[92:95], v[240:243], v[112:115], v[92:95]
    ds_read_b128 v[108:111], v42 offset:768
    s_waitcnt lgkmcnt(6)
    v_mfma_f32_16x16x32_bf16 v[68:71], v[148:151], v[116:119], v[68:71]
    v_mfma_f32_16x16x32_bf16 v[72:75], v[180:183], v[116:119], v[72:75]
    v_mfma_f32_16x16x32_bf16 v[80:83], v[212:215], v[116:119], v[80:83]
    v_mfma_f32_16x16x32_bf16 v[92:95], v[244:247], v[116:119], v[92:95]
    ds_read_b128 v[112:115], v42 offset:704
    s_waitcnt lgkmcnt(6)
    v_mfma_f32_16x16x32_bf16 v[68:71], v[152:155], v[120:123], v[68:71]
    v_mfma_f32_16x16x32_bf16 v[72:75], v[184:187], v[120:123], v[72:75]
    v_mfma_f32_16x16x32_bf16 v[80:83], v[216:219], v[120:123], v[80:83]
    v_mfma_f32_16x16x32_bf16 v[92:95], v[248:251], v[120:123], v[92:95]
    ds_read_b128 v[116:119], v42 offset:640
    s_waitcnt lgkmcnt(6)
    v_mfma_f32_16x16x32_bf16 v[68:71], v[156:159], v[124:127], v[68:71]
    v_mfma_f32_16x16x32_bf16 v[72:75], v[188:191], v[124:127], v[72:75]
    v_mfma_f32_16x16x32_bf16 v[80:83], v[220:223], v[124:127], v[80:83]
    v_mfma_f32_16x16x32_bf16 v[92:95], v[252:255], v[124:127], v[92:95]
    ds_read_b128 v[120:123], v42 offset:576
    s_waitcnt lgkmcnt(6)
    v_mfma_f32_16x16x32_bf16 v[72:75], v[128:131], v[96:99], v[72:75]
    v_mfma_f32_16x16x32_bf16 v[76:79], v[160:163], v[96:99], 0
    v_mfma_f32_16x16x32_bf16 v[84:87], v[192:195], v[96:99], 0
    ds_read_b128 v[124:127], v42 offset:512
    s_waitcnt lgkmcnt(6)
    v_mfma_f32_16x16x32_bf16 v[72:75], v[132:135], v[100:103], v[72:75]
    v_mfma_f32_16x16x32_bf16 v[76:79], v[164:167], v[100:103], v[76:79]
    v_mfma_f32_16x16x32_bf16 v[84:87], v[196:199], v[100:103], v[84:87]
    ds_read_b128 v[96:99], v42 offset:1472
    s_waitcnt lgkmcnt(6)
    v_mfma_f32_16x16x32_bf16 v[72:75], v[136:139], v[104:107], v[72:75]
    v_mfma_f32_16x16x32_bf16 v[76:79], v[168:171], v[104:107], v[76:79]
    v_mfma_f32_16x16x32_bf16 v[84:87], v[200:203], v[104:107], v[84:87]
    ds_read_b128 v[100:103], v42 offset:1408
    s_waitcnt lgkmcnt(6)
    v_mfma_f32_16x16x32_bf16 v[72:75], v[140:143], v[108:111], v[72:75]
    v_mfma_f32_16x16x32_bf16 v[76:79], v[172:175], v[108:111], v[76:79]
    v_mfma_f32_16x16x32_bf16 v[84:87], v[204:207], v[108:111], v[84:87]
    ds_read_b128 v[104:107], v42 offset:1344
    s_waitcnt lgkmcnt(6)
    v_mfma_f32_16x16x32_bf16 v[72:75], v[144:147], v[112:115], v[72:75]
    v_mfma_f32_16x16x32_bf16 v[76:79], v[176:179], v[112:115], v[76:79]
    v_mfma_f32_16x16x32_bf16 v[84:87], v[208:211], v[112:115], v[84:87]
    ds_read_b128 v[108:111], v42 offset:1280
    s_waitcnt lgkmcnt(6)
    v_mfma_f32_16x16x32_bf16 v[72:75], v[148:151], v[116:119], v[72:75]
    v_mfma_f32_16x16x32_bf16 v[76:79], v[180:183], v[116:119], v[76:79]
    v_mfma_f32_16x16x32_bf16 v[84:87], v[212:215], v[116:119], v[84:87]
    ds_read_b128 v[112:115], v42 offset:1216
    s_waitcnt lgkmcnt(6)
    v_mfma_f32_16x16x32_bf16 v[72:75], v[152:155], v[120:123], v[72:75]
    v_mfma_f32_16x16x32_bf16 v[76:79], v[184:187], v[120:123], v[76:79]
    v_mfma_f32_16x16x32_bf16 v[84:87], v[216:219], v[120:123], v[84:87]
    ds_read_b128 v[116:119], v42 offset:1152
    s_waitcnt lgkmcnt(6)
    v_mfma_f32_16x16x32_bf16 v[72:75], v[156:159], v[124:127], v[72:75]
    v_mfma_f32_16x16x32_bf16 v[76:79], v[188:191], v[124:127], v[76:79]
    v_mfma_f32_16x16x32_bf16 v[84:87], v[220:223], v[124:127], v[84:87]
    ds_read_b128 v[120:123], v42 offset:1088
    s_waitcnt lgkmcnt(6)
    v_mfma_f32_16x16x32_bf16 v[76:79], v[128:131], v[96:99], v[76:79]
    v_mfma_f32_16x16x32_bf16 v[80:83], v[160:163], v[96:99], v[80:83]
    v_mfma_f32_16x16x32_bf16 v[88:91], v[192:195], v[96:99], 0
    ds_read_b128 v[124:127], v42 offset:1024
    s_waitcnt lgkmcnt(6)
    v_mfma_f32_16x16x32_bf16 v[76:79], v[132:135], v[100:103], v[76:79]
    v_mfma_f32_16x16x32_bf16 v[80:83], v[164:167], v[100:103], v[80:83]
    v_mfma_f32_16x16x32_bf16 v[88:91], v[196:199], v[100:103], v[88:91]
    ds_read_b128 v[96:99], v42 offset:1984
    s_waitcnt lgkmcnt(6)
    v_mfma_f32_16x16x32_bf16 v[76:79], v[136:139], v[104:107], v[76:79]
    v_mfma_f32_16x16x32_bf16 v[80:83], v[168:171], v[104:107], v[80:83]
    v_mfma_f32_16x16x32_bf16 v[88:91], v[200:203], v[104:107], v[88:91]
    ds_read_b128 v[100:103], v42 offset:1920
    s_waitcnt lgkmcnt(6)
    v_mfma_f32_16x16x32_bf16 v[76:79], v[140:143], v[108:111], v[76:79]
    v_mfma_f32_16x16x32_bf16 v[80:83], v[172:175], v[108:111], v[80:83]
    v_mfma_f32_16x16x32_bf16 v[88:91], v[204:207], v[108:111], v[88:91]
    ds_read_b128 v[104:107], v42 offset:1856
    s_waitcnt lgkmcnt(6)
    v_mfma_f32_16x16x32_bf16 v[76:79], v[144:147], v[112:115], v[76:79]
    v_mfma_f32_16x16x32_bf16 v[80:83], v[176:179], v[112:115], v[80:83]
    v_mfma_f32_16x16x32_bf16 v[88:91], v[208:211], v[112:115], v[88:91]
    ds_read_b128 v[108:111], v42 offset:1792
    s_waitcnt lgkmcnt(6)
    v_mfma_f32_16x16x32_bf16 v[76:79], v[148:151], v[116:119], v[76:79]
    v_mfma_f32_16x16x32_bf16 v[80:83], v[180:183], v[116:119], v[80:83]
    v_mfma_f32_16x16x32_bf16 v[88:91], v[212:215], v[116:119], v[88:91]
    ds_read_b128 v[112:115], v42 offset:1728
    s_waitcnt lgkmcnt(6)
    v_mfma_f32_16x16x32_bf16 v[76:79], v[152:155], v[120:123], v[76:79]
    v_mfma_f32_16x16x32_bf16 v[80:83], v[184:187], v[120:123], v[80:83]
    v_mfma_f32_16x16x32_bf16 v[88:91], v[216:219], v[120:123], v[88:91]
    ds_read_b128 v[116:119], v42 offset:1664
    s_waitcnt lgkmcnt(6)
    v_mfma_f32_16x16x32_bf16 v[76:79], v[156:159], v[124:127], v[76:79]
    v_mfma_f32_16x16x32_bf16 v[80:83], v[188:191], v[124:127], v[80:83]
    v_mfma_f32_16x16x32_bf16 v[88:91], v[220:223], v[124:127], v[88:91]
    ds_read_b128 v[120:123], v42 offset:1600
    s_waitcnt lgkmcnt(6)
    v_mfma_f32_16x16x32_bf16 v[80:83], v[128:131], v[96:99], v[80:83]
    v_mfma_f32_16x16x32_bf16 v[84:87], v[160:163], v[96:99], v[84:87]
    v_mfma_f32_16x16x32_bf16 v[92:95], v[192:195], v[96:99], v[92:95]
    ds_read_b128 v[124:127], v42 offset:1536
    s_waitcnt lgkmcnt(6)
    v_mfma_f32_16x16x32_bf16 v[80:83], v[132:135], v[100:103], v[80:83]
    v_mfma_f32_16x16x32_bf16 v[84:87], v[164:167], v[100:103], v[84:87]
    v_mfma_f32_16x16x32_bf16 v[92:95], v[196:199], v[100:103], v[92:95]
    ds_read_b128 v[96:99], v42 offset:2496
    s_waitcnt lgkmcnt(6)
    v_mfma_f32_16x16x32_bf16 v[80:83], v[136:139], v[104:107], v[80:83]
    v_mfma_f32_16x16x32_bf16 v[84:87], v[168:171], v[104:107], v[84:87]
    v_mfma_f32_16x16x32_bf16 v[92:95], v[200:203], v[104:107], v[92:95]
    ds_read_b128 v[100:103], v42 offset:2432
    s_waitcnt lgkmcnt(6)
    v_mfma_f32_16x16x32_bf16 v[80:83], v[140:143], v[108:111], v[80:83]
    v_mfma_f32_16x16x32_bf16 v[84:87], v[172:175], v[108:111], v[84:87]
    v_mfma_f32_16x16x32_bf16 v[92:95], v[204:207], v[108:111], v[92:95]
    ds_read_b128 v[104:107], v42 offset:2368
    s_waitcnt lgkmcnt(6)
    v_mfma_f32_16x16x32_bf16 v[80:83], v[144:147], v[112:115], v[80:83]
    v_mfma_f32_16x16x32_bf16 v[84:87], v[176:179], v[112:115], v[84:87]
    v_mfma_f32_16x16x32_bf16 v[92:95], v[208:211], v[112:115], v[92:95]
    ds_read_b128 v[108:111], v42 offset:2304
    s_waitcnt lgkmcnt(6)
    v_mfma_f32_16x16x32_bf16 v[80:83], v[148:151], v[116:119], v[80:83]
    v_mfma_f32_16x16x32_bf16 v[84:87], v[180:183], v[116:119], v[84:87]
    v_mfma_f32_16x16x32_bf16 v[92:95], v[212:215], v[116:119], v[92:95]
    ds_read_b128 v[112:115], v42 offset:2240
    s_waitcnt lgkmcnt(6)
    v_mfma_f32_16x16x32_bf16 v[80:83], v[152:155], v[120:123], v[80:83]
    v_mfma_f32_16x16x32_bf16 v[84:87], v[184:187], v[120:123], v[84:87]
    v_mfma_f32_16x16x32_bf16 v[92:95], v[216:219], v[120:123], v[92:95]
    ds_read_b128 v[116:119], v42 offset:2176
    s_waitcnt lgkmcnt(6)
    v_mfma_f32_16x16x32_bf16 v[80:83], v[156:159], v[124:127], v[80:83]
    v_mfma_f32_16x16x32_bf16 v[84:87], v[188:191], v[124:127], v[84:87]
    v_mfma_f32_16x16x32_bf16 v[92:95], v[220:223], v[124:127], v[92:95]
    ds_read_b128 v[120:123], v42 offset:2112
    s_barrier
    ds_read_b128 v[48:51], v45 offset:0
    ds_read_b128 v[52:55], v45 offset:1024
    ds_read_b128 v[56:59], v45 offset:2048
    ds_read_b128 v[60:63], v45 offset:3072
    s_waitcnt lgkmcnt(10)
    v_mfma_f32_16x16x32_bf16 v[84:87], v[128:131], v[96:99], v[84:87]
    v_mfma_f32_16x16x32_bf16 v[88:91], v[160:163], v[96:99], v[88:91]
    ds_read_b128 v[124:127], v42 offset:2048
    s_waitcnt lgkmcnt(10)
    v_mfma_f32_16x16x32_bf16 v[84:87], v[132:135], v[100:103], v[84:87]
    v_mfma_f32_16x16x32_bf16 v[88:91], v[164:167], v[100:103], v[88:91]
    ds_read_b128 v[96:99], v42 offset:3008
    s_waitcnt lgkmcnt(10)
    v_mfma_f32_16x16x32_bf16 v[84:87], v[136:139], v[104:107], v[84:87]
    v_mfma_f32_16x16x32_bf16 v[88:91], v[168:171], v[104:107], v[88:91]
    ds_read_b128 v[100:103], v42 offset:2944
    s_waitcnt lgkmcnt(10)
    v_mfma_f32_16x16x32_bf16 v[84:87], v[140:143], v[108:111], v[84:87]
    v_mfma_f32_16x16x32_bf16 v[88:91], v[172:175], v[108:111], v[88:91]
    ds_read_b128 v[104:107], v42 offset:2880
    s_waitcnt lgkmcnt(4)
    s_waitcnt lgkmcnt(10)
    v_mfma_f32_16x16x32_bf16 v[84:87], v[144:147], v[112:115], v[84:87]
    v_mfma_f32_16x16x32_bf16 v[88:91], v[176:179], v[112:115], v[88:91]
    ds_read_b128 v[108:111], v42 offset:2816
    v_lshlrev_b32 v24, 16, v16
    v_and_b32 v25, s59, v16
    v_lshlrev_b32 v26, 16, v17
    s_waitcnt lgkmcnt(10)
    v_mfma_f32_16x16x32_bf16 v[84:87], v[148:151], v[116:119], v[84:87]
    v_mfma_f32_16x16x32_bf16 v[88:91], v[180:183], v[116:119], v[88:91]
    ds_read_b128 v[112:115], v42 offset:2752
    v_and_b32 v27, s59, v17
    v_fmac_f32 v48, s42, v24
    v_fmac_f32 v49, s42, v25
    s_waitcnt lgkmcnt(10)
    v_mfma_f32_16x16x32_bf16 v[84:87], v[152:155], v[120:123], v[84:87]
    v_mfma_f32_16x16x32_bf16 v[88:91], v[184:187], v[120:123], v[88:91]
    ds_read_b128 v[116:119], v42 offset:2688
    v_fmac_f32 v50, s42, v26
    v_fmac_f32 v51, s42, v27
    v_cvt_pk_bf16_f32 v48, v48, v49
    s_waitcnt lgkmcnt(6)
    v_mfma_f32_16x16x32_bf16 v[84:87], v[156:159], v[124:127], v[84:87]
    v_mfma_f32_16x16x32_bf16 v[88:91], v[188:191], v[124:127], v[88:91]
    ds_read_b128 v[120:123], v42 offset:2624
    v_cvt_pk_bf16_f32 v49, v50, v51
    buffer_store_dwordx2 v[48:49], v43, s[44:47], s48 offen offset:0 sc1
    v_lshlrev_b32_e64 v28, 16, v18
    s_waitcnt lgkmcnt(6)
    v_mfma_f32_16x16x32_bf16 v[88:91], v[128:131], v[96:99], v[88:91]
    v_mfma_f32_16x16x32_bf16 v[92:95], v[160:163], v[96:99], v[92:95]
    ds_read_b128 v[124:127], v42 offset:2560
    v_and_b32 v29, s59, v18
    v_lshlrev_b32 v30, 16, v19
    v_and_b32 v31, s59, v19
    s_waitcnt lgkmcnt(6)
    v_mfma_f32_16x16x32_bf16 v[88:91], v[132:135], v[100:103], v[88:91]
    v_mfma_f32_16x16x32_bf16 v[92:95], v[164:167], v[100:103], v[92:95]
    ds_read_b128 v[96:99], v42 offset:3520
    v_fmac_f32 v52, s42, v28
    v_fmac_f32 v53, s42, v29
    v_fmac_f32 v54, s42, v30
    s_waitcnt lgkmcnt(6)
    v_mfma_f32_16x16x32_bf16 v[88:91], v[136:139], v[104:107], v[88:91]
    v_mfma_f32_16x16x32_bf16 v[92:95], v[168:171], v[104:107], v[92:95]
    ds_read_b128 v[100:103], v42 offset:3456
    v_fmac_f32 v55, s42, v31
    v_add_f32 v52, v52, v68
    v_add_f32 v53, v53, v69
    s_waitcnt lgkmcnt(6)
    v_mfma_f32_16x16x32_bf16 v[88:91], v[140:143], v[108:111], v[88:91]
    v_mfma_f32_16x16x32_bf16 v[92:95], v[172:175], v[108:111], v[92:95]
    ds_read_b128 v[104:107], v42 offset:3392
    v_add_f32 v54, v54, v70
    v_add_f32 v55, v55, v71
    v_cvt_pk_bf16_f32 v52, v52, v53
    s_waitcnt lgkmcnt(6)
    v_mfma_f32_16x16x32_bf16 v[88:91], v[144:147], v[112:115], v[88:91]
    v_mfma_f32_16x16x32_bf16 v[92:95], v[176:179], v[112:115], v[92:95]
    ds_read_b128 v[108:111], v42 offset:3328
    v_cvt_pk_bf16_f32 v53, v54, v55
    buffer_store_dwordx2 v[52:53], v43, s[44:47], s48 offen offset:512 sc1
    v_lshlrev_b32_e64 v24, 16, v20
    s_waitcnt lgkmcnt(6)
    v_mfma_f32_16x16x32_bf16 v[88:91], v[148:151], v[116:119], v[88:91]
    v_mfma_f32_16x16x32_bf16 v[92:95], v[180:183], v[116:119], v[92:95]
    ds_read_b128 v[112:115], v42 offset:3264
    v_and_b32 v25, s59, v20
    v_lshlrev_b32 v26, 16, v21
    v_and_b32 v27, s59, v21
    s_waitcnt lgkmcnt(6)
    v_mfma_f32_16x16x32_bf16 v[88:91], v[152:155], v[120:123], v[88:91]
    v_mfma_f32_16x16x32_bf16 v[92:95], v[184:187], v[120:123], v[92:95]
    ds_read_b128 v[116:119], v42 offset:3200
    v_fmac_f32 v56, s42, v24
    v_fmac_f32 v57, s42, v25
    v_fmac_f32 v58, s42, v26
    s_waitcnt lgkmcnt(6)
    v_mfma_f32_16x16x32_bf16 v[88:91], v[156:159], v[124:127], v[88:91]
    v_mfma_f32_16x16x32_bf16 v[92:95], v[188:191], v[124:127], v[92:95]
    ds_read_b128 v[120:123], v42 offset:3136
    v_fmac_f32 v59, s42, v27
    v_add_f32 v56, v56, v72
    v_add_f32 v57, v57, v73
    s_waitcnt lgkmcnt(6)
    v_mfma_f32_16x16x32_bf16 v[92:95], v[128:131], v[96:99], v[92:95]
    ds_read_b128 v[124:127], v42 offset:3072
    v_add_f32 v58, v58, v74
    v_add_f32 v59, v59, v75
    v_cvt_pk_bf16_f32 v56, v56, v57
    s_waitcnt lgkmcnt(6)
    v_mfma_f32_16x16x32_bf16 v[92:95], v[132:135], v[100:103], v[92:95]
    v_cvt_pk_bf16_f32 v57, v58, v59
    buffer_store_dwordx2 v[56:57], v43, s[44:47], s48 offen offset:1024 sc1
    v_lshlrev_b32_e64 v28, 16, v22
    s_waitcnt lgkmcnt(5)
    v_mfma_f32_16x16x32_bf16 v[92:95], v[136:139], v[104:107], v[92:95]
    v_and_b32 v29, s59, v22
    v_lshlrev_b32 v30, 16, v23
    v_and_b32 v31, s59, v23
    s_waitcnt lgkmcnt(4)
    v_mfma_f32_16x16x32_bf16 v[92:95], v[140:143], v[108:111], v[92:95]
    v_fmac_f32 v60, s42, v28
    v_fmac_f32 v61, s42, v29
    v_fmac_f32 v62, s42, v30
    s_waitcnt lgkmcnt(3)
    v_mfma_f32_16x16x32_bf16 v[92:95], v[144:147], v[112:115], v[92:95]
    v_fmac_f32 v63, s42, v31
    v_add_f32 v60, v60, v76
    v_add_f32 v61, v61, v77
    s_waitcnt lgkmcnt(2)
    v_mfma_f32_16x16x32_bf16 v[92:95], v[148:151], v[116:119], v[92:95]
    v_add_f32 v62, v62, v78
    v_add_f32 v63, v63, v79
    v_cvt_pk_bf16_f32 v60, v60, v61
    s_waitcnt lgkmcnt(1)
    v_mfma_f32_16x16x32_bf16 v[92:95], v[152:155], v[120:123], v[92:95]
    v_cvt_pk_bf16_f32 v61, v62, v63
    buffer_store_dwordx2 v[60:61], v43, s[44:47], s48 offen offset:1536 sc1
    s_waitcnt lgkmcnt(0)
    v_mfma_f32_16x16x32_bf16 v[92:95], v[156:159], v[124:127], v[92:95]
    ds_write_b128 v45, v[80:83] offset:4096
    ds_write_b128 v45, v[84:87] offset:5120
    ds_write_b128 v45, v[88:91] offset:6144
    s_nop 4
    ds_write_b128 v45, v[92:95] offset:7168
    s_waitcnt lgkmcnt(0)
    s_barrier
L_K_pub:
    s_waitcnt vmcnt(0)
    s_barrier
    s_cmp_lg_u32 s28, 0
    s_cbranch_scc1 L_K_end
    s_lshl_b32 s71, s29, 7
    s_add_u32 s71, s71, 0xc20000
    v_mov_b32 v8, s51
    v_mov_b32_e64 v9, 0
    s_mov_b64 exec, 1
    buffer_store_dword v8, v9, s[44:47], s71 offen sc1
    s_mov_b64 exec, -1
L_K_end:
    s_endpgm
L_Kend:
L_second:
    s_cmp_ge_u32 s2, 512
    s_cbranch_scc0 L_M
    s_endpgm
L_M:
    s_setprio 1
    s_load_dwordx2 s[4:5], s[0:1], 0
    s_load_dwordx8 s[8:15], s[0:1], 80
    s_load_dwordx4 s[16:19], s[0:1], 112
    s_load_dwordx2 s[20:21], s[0:1], 128
    s_getpc_b64 s[74:75]
    s_bfe_u32 s72, s2, 0x50003
    s_mul_i32 s72, s72, 512
    v_lshlrev_b32 v3, 7, v0
    v_add_u32 v3, s72, v3
    v_min_u32 v3, 15280, v3
    v_cmp_gt_u32_e64 vcc, 4, v0
    s_nop 0
    s_and_saveexec_b64 s[72:73], vcc
    global_load_dword v3, v3, s[74:75]
    s_mov_b64 exec, s[72:73]
    v_and_b32 v1, 63, v0
    v_lshrrev_b32_e64 v2, 6, v0
    s_nop 0
    v_readfirstlane_b32 s22, v2
    s_and_b32 s3, s2, 255
    s_and_b32 s23, s3, 7
    s_lshr_b32 s48, s3, 3
    s_lshr_b32 s49, s23, 1
    s_lshl_b32 s49, s49, 2
    s_lshr_b32 s76, s48, 3
    s_add_u32 s49, s49, s76
    s_and_b32 s50, s23, 1
    s_lshl_b32 s50, s50, 3
    s_and_b32 s52, s48, 7
    s_add_u32 s50, s50, s52
    s_lshl_b32 s76, s76, 1
    s_mov_b32 s76, 0
    s_lshl_b32 s51, s23, 2
    s_lshr_b32 s52, s48, 3
    s_add_u32 s51, s51, s52
    s_and_b32 s52, s48, 7
    s_lshl_b32 s53, s49, 2
    s_add_u32 s53, s53, s22
    v_lshlrev_b32 v2, 4, v1
    v_lshrrev_b32 v4, 5, v1
    v_and_b32 v5, 31, v1
    v_lshrrev_b32 v9, 3, v1
    v_lshrrev_b32 v10, 4, v1
    v_and_b32 v11, 7, v1
    v_xor_b32 v10, v10, v11
    v_lshlrev_b32 v9, 10, v9
    v_lshl_add_u32 v12, v10, 4, v9
    v_xor_b32_e64 v13, 64, v12
    v_bfe_u32 v10, v1, 4, 1
    v_lshlrev_b32 v10, 2, v10
    v_xor_b32 v10, v10, v11
    v_lshl_add_u32 v15, v10, 4, v9
    s_mov_b32 s54, 43691
    v_add_u32 v9, 0, v1
    v_mul_u32_u24 v10, s54, v9
    v_lshrrev_b32 v10, 19, v10
    v_mul_u32_u24 v11, 12, v10
    v_sub_u32_e64 v9, v9, v11
    v_mul_u32_u24 v10, 2752, v10
    v_lshl_add_u32 v6, v9, 4, v10
    v_add_u32 v9, 64, v1
    v_mul_u32_u24 v10, s54, v9
    v_lshrrev_b32 v10, 19, v10
    v_mul_u32_u24 v11, 12, v10
    v_sub_u32_e64 v9, v9, v11
    v_mul_u32_u24 v10, 2752, v10
    v_lshl_add_u32 v7, v9, 4, v10
    v_add_u32 v9, 128, v1
    v_mul_u32_u24 v10, s54, v9
    v_lshrrev_b32 v10, 19, v10
    v_mul_u32_u24 v11, 12, v10
    v_sub_u32 v9, v9, v11
    v_mul_u32_u24 v10, 2752, v10
    v_lshl_add_u32 v8, v9, 4, v10
    v_lshlrev_b32_e64 v14, 7, v5
    s_mul_i32 s55, s50, 192
    s_mul_i32 s56, s22, 44032
    s_add_u32 s56, s56, s55
    s_mul_i32 s57, s22, 3072
    s_lshl_b32 s67, s53, 15
    s_lshl_b32 s61, s22, 12
    s_add_u32 s61, s61, 49152
    s_lshl_b32 s62, s49, 17
    s_lshl_b32 s63, s52, 14
    s_add_u32 s62, s62, s63
    s_lshl_b32 s63, s22, 12
    s_add_u32 s62, s62, s63
    s_waitcnt lgkmcnt(0)
    s_mov_b32 s40, s4
    s_mov_b32 s41, s5
    s_mov_b32 s42, 0x200000
    s_mov_b32 s43, 0x20000
    s_mov_b32 s28, s8
    s_mov_b32 s29, s9
    s_mov_b32 s30, 0x158000
    s_mov_b32 s31, 0x20000
    s_mov_b32 exec_hi, 0
    s_mov_b64 exec, -1
    s_cmp_eq_u32 s50, 15
    s_cbranch_scc1 L_M_now1
    s_add_u32 m0, s61, 0
    s_add_u32 s77, s76, 0
    s_and_b32 s77, s77, 7
    s_lshl_b32 s77, s77, 7
    s_add_u32 s77, s77, s67
    s_add_u32 s63, s77, 0
    buffer_load_dwordx4 v12, s[40:43], s63 offen lds
    s_add_u32 m0, s61, 1024
    s_add_u32 s63, s77, 8192
    buffer_load_dwordx4 v13, s[40:43], s63 offen lds
    s_add_u32 m0, s61, 2048
    s_add_u32 s63, s77, 16384
    buffer_load_dwordx4 v12, s[40:43], s63 offen lds
    s_add_u32 m0, s61, 3072
    s_add_u32 s63, s77, 24576
    buffer_load_dwordx4 v13, s[40:43], s63 offen lds
    s_mov_b32 s36, s10
    s_mov_b32 s37, s11
    s_mov_b32 s38, 0xac0
    s_mov_b32 s39, 0x20000
    s_mov_b32 m0, 36864
    s_mov_b64 exec, 0xfff
    buffer_load_dwordx4 v2, s[36:39], s55 offen lds
    s_mov_b64 exec, -1
    s_add_u32 s78, s76, 0
    s_and_b32 s78, s78, 7
    s_mul_i32 s78, s78, 176128
    s_add_u32 s78, s78, s56
    s_add_u32 m0, s57, 0
    s_nop 0
    buffer_load_dwordx4 v6, s[28:31], s78 offen lds
    s_add_u32 m0, s57, 1024
    s_nop 0
    buffer_load_dwordx4 v7, s[28:31], s78 offen lds
    s_add_u32 m0, s57, 2048
    s_nop 0
    buffer_load_dwordx4 v8, s[28:31], s78 offen lds
    s_add_u32 m0, s61, 16384
    s_add_u32 s77, s76, 1
    s_and_b32 s77, s77, 7
    s_lshl_b32 s77, s77, 7
    s_add_u32 s77, s77, s67
    s_add_u32 s63, s77, 0
    buffer_load_dwordx4 v12, s[40:43], s63 offen lds
    s_add_u32 m0, s61, 17408
    s_add_u32 s63, s77, 8192
    buffer_load_dwordx4 v13, s[40:43], s63 offen lds
    s_add_u32 m0, s61, 18432
    s_add_u32 s63, s77, 16384
    buffer_load_dwordx4 v12, s[40:43], s63 offen lds
    s_add_u32 m0, s61, 19456
    s_add_u32 s63, s77, 24576
    buffer_load_dwordx4 v13, s[40:43], s63 offen lds
    s_add_u32 s78, s76, 1
    s_and_b32 s78, s78, 7
    s_mul_i32 s78, s78, 176128
    s_add_u32 s78, s78, s56
    s_add_u32 m0, s57, 12288
    s_nop 0
    buffer_load_dwordx4 v6, s[28:31], s78 offen lds
    s_add_u32 m0, s57, 13312
    s_nop 0
    buffer_load_dwordx4 v7, s[28:31], s78 offen lds
    s_add_u32 m0, s57, 14336
    s_nop 0
    buffer_load_dwordx4 v8, s[28:31], s78 offen lds
    s_add_u32 s78, s76, 2
    s_and_b32 s78, s78, 7
    s_mul_i32 s78, s78, 176128
    s_add_u32 s78, s78, s56
    s_add_u32 m0, s57, 24576
    s_nop 0
    buffer_load_dwordx4 v6, s[28:31], s78 offen lds
    s_add_u32 m0, s57, 25600
    s_nop 0
    buffer_load_dwordx4 v7, s[28:31], s78 offen lds
    s_add_u32 m0, s57, 26624
    s_nop 0
    buffer_load_dwordx4 v8, s[28:31], s78 offen lds
L_M_now1:
    s_mov_b32 s24, s20
    s_mov_b32 s25, s21
    s_mov_b32 s26, 0xf00000
    s_mov_b32 s27, 0x20000
    s_mov_b32 s44, s16
    s_mov_b32 s45, s17
    s_mov_b32 s46, 0x200000
    s_mov_b32 s47, 0x20000
    s_mov_b32 s32, s12
    s_mov_b32 s33, s13
    s_mov_b32 s34, 0x158000
    s_mov_b32 s35, 0x20000
    s_mov_b32 s64, 0xffff0000
    s_mov_b32 s69, 0x3f803f80
    v_mov_b32 v10, 0
    s_mul_i32 s58, s22, 22
    s_cmp_eq_u32 s22, 3
    s_cselect_b32 s59, 1, 0
    s_sub_u32 s58, s58, s59
    s_lshl_b32 s59, s58, 14
    s_lshl_b32 s60, s52, 7
    s_add_u32 s59, s59, s60
    s_cmp_lt_u32 s22, 2
    s_cselect_b32 s48, 22, 21
    s_mul_i32 s79, s52, 2
    s_and_b32 s63, s51, 3
    s_mul_i32 s63, s63, 5
    s_add_u32 s79, s79, s63
    s_cmp_ge_u32 s79, 21
    s_cselect_b32 s63, 21, 0
    s_sub_u32 s79, s79, s63
    v_and_b32 v9, 1, v1
    v_lshl_add_u32 v9, v4, 2, v9
    v_lshlrev_b32 v9, 10, v9
    v_lshrrev_b32 v11, 1, v5
    v_lshl_add_u32 v9, v11, 2, v9
    v_bfe_u32 v14, v1, 1, 3
    v_xor_b32 v14, v14, v4
    s_lshl_b32 s63, s22, 1
    v_xor_b32 v14, s63, v14
    v_lshlrev_b32 v16, 7, v5
    v_add_u32_e64 v16, s61, v16
    v_lshl_add_u32 v244, v14, 4, v16
    v_xor_b32_e64 v11, 2, v14
    v_lshl_add_u32 v245, v11, 4, v16
    v_xor_b32_e64 v11, 4, v14
    v_lshl_add_u32 v246, v11, 4, v16
    v_xor_b32_e64 v11, 6, v14
    v_lshl_add_u32 v247, v11, 4, v16
    v_bfe_u32 v16, v1, 2, 2
    v_bfe_u32 v17, v1, 4, 1
    v_and_b32 v18, 3, v1
    v_lshlrev_b32 v18, 3, v18
    v_lshl_add_u32 v17, v17, 5, v18
    v_lshl_add_u32 v14, v4, 3, v16
    v_mul_u32_u24 v14, 192, v14
    v_add_u32 v14, v14, v17
    s_xor_b32 s63, s22, 0
    s_mul_i32 s63, s63, 3072
    v_add_u32 v248, s63, v14
    s_xor_b32 s63, s22, 1
    s_mul_i32 s63, s63, 3072
    v_add_u32 v249, s63, v14
    s_xor_b32 s63, s22, 2
    s_mul_i32 s63, s63, 3072
    v_add_u32 v250, s63, v14
    s_xor_b32 s63, s22, 3
    s_mul_i32 s63, s63, 3072
    v_add_u32_e64 v251, s63, v14
    v_lshl_add_u32 v14, v4, 2, v16
    v_lshl_add_u32 v14, v14, 7, v17
    v_bfe_u32 v16, v1, 3, 1
    v_lshl_add_u32 v14, v16, 6, v14
    v_xor_b32 v16, 64, v14
    v_add_u32 v252, s57, v14
    v_add_u32 v253, s57, v16
    v_add_u32 v254, s61, v14
    v_add_u32 v255, s61, v16
    s_cmp_eq_u32 s50, 15
    s_cbranch_scc1 L_M_g15
    v_mov_b32 v98, s69
    v_mov_b32_e64 v99, s69
    s_mul_i32 s68, s53, 86
    s_mul_i32 s63, s50, 6
    s_add_u32 s68, s68, s63
    s_lshl_b32 s68, s68, 10
    s_add_u32 s68, s68, 0x400000
    s_add_u32 s66, s68, 4096
    s_cmp_eq_u32 s50, 14
    s_cselect_b32 s66, 0x7f000000, s66
    s_cselect_b32 s73, 0x7f000000, s68
    s_lshl_b32 s74, s53, 9
    s_add_u32 s74, s74, 0xc60000
    v_mov_b32 v66, 0
    v_mov_b32 v67, 0
    v_mov_b32 v70, 0
    v_mov_b32 v71, 0
    v_mov_b32 v74, 0
    v_mov_b32 v75, 0
    v_mov_b32 v78, 0
    v_mov_b32 v79, 0
    s_waitcnt vmcnt(10)
    s_barrier
    s_setprio 3
    ds_read_b128 v[176:179], v244 offset:0
    ds_read_b128 v[180:183], v245 offset:0
    ds_read_b128 v[184:187], v246 offset:0
    ds_read_b128 v[188:191], v247 offset:0
    v_lshlrev_b32_e64 v3, 1, v5
    ds_read_u16 v231, v3 offset:36864
    ds_read_u16 v232, v3 offset:36928
    ds_read_u16 v233, v3 offset:36992
    v_lshlrev_b32_e64 v3, 4, v5
    ds_read_b64_tr_b16 v[208:209], v248 offset:0
    ds_read_b64_tr_b16 v[210:211], v248 offset:768
    ds_read_b64_tr_b16 v[212:213], v248 offset:64
    ds_read_b64_tr_b16 v[214:215], v248 offset:832
    ds_read_b64_tr_b16 v[216:217], v248 offset:128
    ds_read_b64_tr_b16 v[218:219], v248 offset:896
    ds_read_b64_tr_b16 v[220:221], v249 offset:0
    ds_read_b64_tr_b16 v[222:223], v249 offset:768
    s_waitcnt lgkmcnt(6)
    v_mfma_f32_32x32x16_bf16 v[128:143], v[208:211], v[176:179], 0
    v_mfma_f32_4x4x4_16b_bf16 v[100:103], v[98:99], v[208:209], 0
    ds_read_b64_tr_b16 v[224:225], v249 offset:64
    ds_read_b64_tr_b16 v[226:227], v249 offset:832
    v_mfma_f32_4x4x4_16b_bf16 v[100:103], v[98:99], v[210:211], v[100:103]
    s_waitcnt lgkmcnt(6)
    v_mfma_f32_32x32x16_bf16 v[144:159], v[212:215], v[176:179], 0
    v_mfma_f32_4x4x4_16b_bf16 v[104:107], v[98:99], v[212:213], 0
    ds_read_b64_tr_b16 v[208:209], v249 offset:128
    ds_read_b64_tr_b16 v[210:211], v249 offset:896
    v_mfma_f32_4x4x4_16b_bf16 v[104:107], v[98:99], v[214:215], v[104:107]
    s_waitcnt lgkmcnt(6)
    v_mfma_f32_32x32x16_bf16 v[160:175], v[216:219], v[176:179], 0
    v_mfma_f32_4x4x4_16b_bf16 v[108:111], v[98:99], v[216:217], 0
    ds_read_b64_tr_b16 v[212:213], v250 offset:0
    ds_read_b64_tr_b16 v[214:215], v250 offset:768
    v_mfma_f32_4x4x4_16b_bf16 v[108:111], v[98:99], v[218:219], v[108:111]
    s_add_u32 m0, s61, 0
    s_add_u32 s77, s76, 2
    s_and_b32 s77, s77, 7
    s_lshl_b32 s77, s77, 7
    s_add_u32 s77, s77, s67
    s_add_u32 s63, s77, 0
    buffer_load_dwordx4 v12, s[40:43], s63 offen lds
    s_waitcnt lgkmcnt(6)
    v_mfma_f32_32x32x16_bf16 v[128:143], v[220:223], v[180:183], v[128:143]
    ds_read_b64_tr_b16 v[216:217], v250 offset:64
    ds_read_b64_tr_b16 v[218:219], v250 offset:832
    s_add_u32 m0, s61, 1024
    s_add_u32 s63, s77, 8192
    buffer_load_dwordx4 v13, s[40:43], s63 offen lds
    s_waitcnt lgkmcnt(6)
    v_mfma_f32_32x32x16_bf16 v[144:159], v[224:227], v[180:183], v[144:159]
    ds_read_b64_tr_b16 v[220:221], v250 offset:128
    ds_read_b64_tr_b16 v[222:223], v250 offset:896
    s_waitcnt lgkmcnt(6)
    v_mfma_f32_32x32x16_bf16 v[160:175], v[208:211], v[180:183], v[160:175]
    ds_read_b64_tr_b16 v[224:225], v251 offset:0
    ds_read_b64_tr_b16 v[226:227], v251 offset:768
    s_add_u32 m0, s61, 2048
    s_add_u32 s63, s77, 16384
    buffer_load_dwordx4 v12, s[40:43], s63 offen lds
    s_waitcnt lgkmcnt(6)
    v_mfma_f32_32x32x16_bf16 v[128:143], v[212:215], v[184:187], v[128:143]
    ds_read_b64_tr_b16 v[208:209], v251 offset:64
    ds_read_b64_tr_b16 v[210:211], v251 offset:832
    s_add_u32 m0, s61, 3072
    s_add_u32 s63, s77, 24576
    buffer_load_dwordx4 v13, s[40:43], s63 offen lds
    s_waitcnt lgkmcnt(6)
    v_mfma_f32_32x32x16_bf16 v[144:159], v[216:219], v[184:187], v[144:159]
    s_waitcnt vmcnt(7)
    s_barrier
    ds_read_b128 v[192:195], v244 offset:16384
    ds_read_b64_tr_b16 v[212:213], v251 offset:128
    ds_read_b64_tr_b16 v[214:215], v251 offset:896
    s_add_u32 s78, s76, 3
    s_and_b32 s78, s78, 7
    s_mul_i32 s78, s78, 176128
    s_add_u32 s78, s78, s56
    s_add_u32 m0, s57, 36864
    s_nop 0
    buffer_load_dwordx4 v6, s[28:31], s78 offen lds
    s_waitcnt lgkmcnt(7)
    v_mfma_f32_32x32x16_bf16 v[160:175], v[220:223], v[184:187], v[160:175]
    ds_read_b128 v[196:199], v245 offset:16384
    ds_read_b64_tr_b16 v[216:217], v248 offset:12288
    ds_read_b64_tr_b16 v[218:219], v248 offset:13056
    s_waitcnt lgkmcnt(8)
    v_mfma_f32_32x32x16_bf16 v[128:143], v[224:227], v[188:191], v[128:143]
    ds_read_b128 v[200:203], v246 offset:16384
    ds_read_b64_tr_b16 v[220:221], v248 offset:12352
    ds_read_b64_tr_b16 v[222:223], v248 offset:13120
    s_add_u32 m0, s57, 37888
    s_nop 0
    buffer_load_dwordx4 v7, s[28:31], s78 offen lds
    s_waitcnt lgkmcnt(9)
    v_mfma_f32_32x32x16_bf16 v[144:159], v[208:211], v[188:191], v[144:159]
    ds_read_b128 v[204:207], v247 offset:16384
    ds_read_b64_tr_b16 v[224:225], v248 offset:12416
    ds_read_b64_tr_b16 v[226:227], v248 offset:13184
    s_add_u32 m0, s57, 38912
    s_nop 0
    buffer_load_dwordx4 v8, s[28:31], s78 offen lds
    s_waitcnt lgkmcnt(9)
    v_mfma_f32_32x32x16_bf16 v[160:175], v[212:215], v[188:191], v[160:175]
    ds_read_b64_tr_b16 v[208:209], v249 offset:12288
    ds_read_b64_tr_b16 v[210:211], v249 offset:13056
    s_waitcnt lgkmcnt(8)
    v_mfma_f32_32x32x16_bf16 v[128:143], v[216:219], v[192:195], v[128:143]
    v_mfma_f32_4x4x4_16b_bf16 v[100:103], v[98:99], v[216:217], v[100:103]
    ds_read_b64_tr_b16 v[212:213], v249 offset:12352
    ds_read_b64_tr_b16 v[214:215], v249 offset:13120
    v_mfma_f32_4x4x4_16b_bf16 v[100:103], v[98:99], v[218:219], v[100:103]
    s_waitcnt lgkmcnt(7)
    v_mfma_f32_32x32x16_bf16 v[144:159], v[220:223], v[192:195], v[144:159]
    v_mfma_f32_4x4x4_16b_bf16 v[104:107], v[98:99], v[220:221], v[104:107]
    ds_read_b64_tr_b16 v[216:217], v249 offset:12416
    ds_read_b64_tr_b16 v[218:219], v249 offset:13184
    v_mfma_f32_4x4x4_16b_bf16 v[104:107], v[98:99], v[222:223], v[104:107]
    s_waitcnt lgkmcnt(6)
    v_mfma_f32_32x32x16_bf16 v[160:175], v[224:227], v[192:195], v[160:175]
    v_mfma_f32_4x4x4_16b_bf16 v[108:111], v[98:99], v[224:225], v[108:111]
    ds_read_b64_tr_b16 v[220:221], v250 offset:12288
    ds_read_b64_tr_b16 v[222:223], v250 offset:13056
    v_mfma_f32_4x4x4_16b_bf16 v[108:111], v[98:99], v[226:227], v[108:111]
    s_add_u32 m0, s61, 16384
    s_add_u32 s77, s76, 3
    s_and_b32 s77, s77, 7
    s_lshl_b32 s77, s77, 7
    s_add_u32 s77, s77, s67
    s_add_u32 s63, s77, 0
    buffer_load_dwordx4 v12, s[40:43], s63 offen lds
    s_waitcnt lgkmcnt(6)
    v_mfma_f32_32x32x16_bf16 v[128:143], v[208:211], v[196:199], v[128:143]
    ds_read_b64_tr_b16 v[224:225], v250 offset:12352
    ds_read_b64_tr_b16 v[226:227], v250 offset:13120
    s_add_u32 m0, s61, 17408
    s_add_u32 s63, s77, 8192
    buffer_load_dwordx4 v13, s[40:43], s63 offen lds
    s_waitcnt lgkmcnt(6)
    v_mfma_f32_32x32x16_bf16 v[144:159], v[212:215], v[196:199], v[144:159]
    ds_read_b64_tr_b16 v[208:209], v250 offset:12416
    ds_read_b64_tr_b16 v[210:211], v250 offset:13184
    s_waitcnt lgkmcnt(6)
    v_mfma_f32_32x32x16_bf16 v[160:175], v[216:219], v[196:199], v[160:175]
    ds_read_b64_tr_b16 v[212:213], v251 offset:12288
    ds_read_b64_tr_b16 v[214:215], v251 offset:13056
    s_add_u32 m0, s61, 18432
    s_add_u32 s63, s77, 16384
    buffer_load_dwordx4 v12, s[40:43], s63 offen lds
    s_waitcnt lgkmcnt(6)
    v_mfma_f32_32x32x16_bf16 v[128:143], v[220:223], v[200:203], v[128:143]
    ds_read_b64_tr_b16 v[216:217], v251 offset:12352
    ds_read_b64_tr_b16 v[218:219], v251 offset:13120
    s_add_u32 m0, s61, 19456
    s_add_u32 s63, s77, 24576
    buffer_load_dwordx4 v13, s[40:43], s63 offen lds
    s_waitcnt lgkmcnt(6)
    v_mfma_f32_32x32x16_bf16 v[144:159], v[224:227], v[200:203], v[144:159]
    s_waitcnt vmcnt(7)
    s_barrier
    ds_read_b128 v[176:179], v244 offset:0
    ds_read_b64_tr_b16 v[220:221], v251 offset:12416
    ds_read_b64_tr_b16 v[222:223], v251 offset:13184
    s_add_u32 s78, s76, 4
    s_and_b32 s78, s78, 7
    s_mul_i32 s78, s78, 176128
    s_add_u32 s78, s78, s56
    s_add_u32 m0, s57, 0
    s_nop 0
    buffer_load_dwordx4 v6, s[28:31], s78 offen lds
    s_waitcnt lgkmcnt(7)
    v_mfma_f32_32x32x16_bf16 v[160:175], v[208:211], v[200:203], v[160:175]
    ds_read_b128 v[180:183], v245 offset:0
    ds_read_b64_tr_b16 v[224:225], v248 offset:24576
    ds_read_b64_tr_b16 v[226:227], v248 offset:25344
    s_waitcnt lgkmcnt(8)
    v_mfma_f32_32x32x16_bf16 v[128:143], v[212:215], v[204:207], v[128:143]
    ds_read_b128 v[184:187], v246 offset:0
    ds_read_b64_tr_b16 v[208:209], v248 offset:24640
    ds_read_b64_tr_b16 v[210:211], v248 offset:25408
    s_add_u32 m0, s57, 1024
    s_nop 0
    buffer_load_dwordx4 v7, s[28:31], s78 offen lds
    s_waitcnt lgkmcnt(9)
    v_mfma_f32_32x32x16_bf16 v[144:159], v[216:219], v[204:207], v[144:159]
    ds_read_b128 v[188:191], v247 offset:0
    ds_read_b64_tr_b16 v[212:213], v248 offset:24704
    ds_read_b64_tr_b16 v[214:215], v248 offset:25472
    s_add_u32 m0, s57, 2048
    s_nop 0
    buffer_load_dwordx4 v8, s[28:31], s78 offen lds
    s_waitcnt lgkmcnt(9)
    v_mfma_f32_32x32x16_bf16 v[160:175], v[220:223], v[204:207], v[160:175]
    ds_read_b64_tr_b16 v[216:217], v249 offset:24576
    ds_read_b64_tr_b16 v[218:219], v249 offset:25344
    s_waitcnt lgkmcnt(8)
    v_mfma_f32_32x32x16_bf16 v[128:143], v[224:227], v[176:179], v[128:143]
    v_mfma_f32_4x4x4_16b_bf16 v[100:103], v[98:99], v[224:225], v[100:103]
    ds_read_b64_tr_b16 v[220:221], v249 offset:24640
    ds_read_b64_tr_b16 v[222:223], v249 offset:25408
    v_mfma_f32_4x4x4_16b_bf16 v[100:103], v[98:99], v[226:227], v[100:103]
    s_waitcnt lgkmcnt(7)
    v_mfma_f32_32x32x16_bf16 v[144:159], v[208:211], v[176:179], v[144:159]
    v_mfma_f32_4x4x4_16b_bf16 v[104:107], v[98:99], v[208:209], v[104:107]
    ds_read_b64_tr_b16 v[224:225], v249 offset:24704
    ds_read_b64_tr_b16 v[226:227], v249 offset:25472
    v_mfma_f32_4x4x4_16b_bf16 v[104:107], v[98:99], v[210:211], v[104:107]
    s_waitcnt lgkmcnt(6)
    v_mfma_f32_32x32x16_bf16 v[160:175], v[212:215], v[176:179], v[160:175]
    v_mfma_f32_4x4x4_16b_bf16 v[108:111], v[98:99], v[212:213], v[108:111]
    ds_read_b64_tr_b16 v[208:209], v250 offset:24576
    ds_read_b64_tr_b16 v[210:211], v250 offset:25344
    v_mfma_f32_4x4x4_16b_bf16 v[108:111], v[98:99], v[214:215], v[108:111]
    s_add_u32 m0, s61, 0
    s_add_u32 s77, s76, 4
    s_and_b32 s77, s77, 7
    s_lshl_b32 s77, s77, 7
    s_add_u32 s77, s77, s67
    s_add_u32 s63, s77, 0
    buffer_load_dwordx4 v12, s[40:43], s63 offen lds
    s_waitcnt lgkmcnt(6)
    v_mfma_f32_32x32x16_bf16 v[128:143], v[216:219], v[180:183], v[128:143]
    ds_read_b64_tr_b16 v[212:213], v250 offset:24640
    ds_read_b64_tr_b16 v[214:215], v250 offset:25408
    s_add_u32 m0, s61, 1024
    s_add_u32 s63, s77, 8192
    buffer_load_dwordx4 v13, s[40:43], s63 offen lds
    s_waitcnt lgkmcnt(6)
    v_mfma_f32_32x32x16_bf16 v[144:159], v[220:223], v[180:183], v[144:159]
    ds_read_b64_tr_b16 v[216:217], v250 offset:24704
    ds_read_b64_tr_b16 v[218:219], v250 offset:25472
    s_waitcnt lgkmcnt(6)
    v_mfma_f32_32x32x16_bf16 v[160:175], v[224:227], v[180:183], v[160:175]
    ds_read_b64_tr_b16 v[220:221], v251 offset:24576
    ds_read_b64_tr_b16 v[222:223], v251 offset:25344
    s_add_u32 m0, s61, 2048
    s_add_u32 s63, s77, 16384
    buffer_load_dwordx4 v12, s[40:43], s63 offen lds
    s_waitcnt lgkmcnt(6)
    v_mfma_f32_32x32x16_bf16 v[128:143], v[208:211], v[184:187], v[128:143]
    ds_read_b64_tr_b16 v[224:225], v251 offset:24640
    ds_read_b64_tr_b16 v[226:227], v251 offset:25408
    s_add_u32 m0, s61, 3072
    s_add_u32 s63, s77, 24576
    buffer_load_dwordx4 v13, s[40:43], s63 offen lds
    s_waitcnt lgkmcnt(6)
    v_mfma_f32_32x32x16_bf16 v[144:159], v[212:215], v[184:187], v[144:159]
    s_waitcnt vmcnt(7)
    s_barrier
    ds_read_b128 v[192:195], v244 offset:16384
    ds_read_b64_tr_b16 v[208:209], v251 offset:24704
    ds_read_b64_tr_b16 v[210:211], v251 offset:25472
    s_add_u32 s78, s76, 5
    s_and_b32 s78, s78, 7
    s_mul_i32 s78, s78, 176128
    s_add_u32 s78, s78, s56
    s_add_u32 m0, s57, 12288
    s_nop 0
    buffer_load_dwordx4 v6, s[28:31], s78 offen lds
    s_waitcnt lgkmcnt(7)
    v_mfma_f32_32x32x16_bf16 v[160:175], v[216:219], v[184:187], v[160:175]
    ds_read_b128 v[196:199], v245 offset:16384
    ds_read_b64_tr_b16 v[212:213], v248 offset:36864
    ds_read_b64_tr_b16 v[214:215], v248 offset:37632
    s_waitcnt lgkmcnt(8)
    v_mfma_f32_32x32x16_bf16 v[128:143], v[220:223], v[188:191], v[128:143]
    ds_read_b128 v[200:203], v246 offset:16384
    ds_read_b64_tr_b16 v[216:217], v248 offset:36928
    ds_read_b64_tr_b16 v[218:219], v248 offset:37696
    s_add_u32 m0, s57, 13312
    s_nop 0
    buffer_load_dwordx4 v7, s[28:31], s78 offen lds
    s_waitcnt lgkmcnt(9)
    v_mfma_f32_32x32x16_bf16 v[144:159], v[224:227], v[188:191], v[144:159]
    ds_read_b128 v[204:207], v247 offset:16384
    ds_read_b64_tr_b16 v[220:221], v248 offset:36992
    ds_read_b64_tr_b16 v[222:223], v248 offset:37760
    s_add_u32 m0, s57, 14336
    s_nop 0
    buffer_load_dwordx4 v8, s[28:31], s78 offen lds
    s_waitcnt lgkmcnt(9)
    v_mfma_f32_32x32x16_bf16 v[160:175], v[208:211], v[188:191], v[160:175]
    ds_read_b64_tr_b16 v[224:225], v249 offset:36864
    ds_read_b64_tr_b16 v[226:227], v249 offset:37632
    s_waitcnt lgkmcnt(8)
    v_mfma_f32_32x32x16_bf16 v[128:143], v[212:215], v[192:195], v[128:143]
    v_mfma_f32_4x4x4_16b_bf16 v[100:103], v[98:99], v[212:213], v[100:103]
    ds_read_b64_tr_b16 v[208:209], v249 offset:36928
    ds_read_b64_tr_b16 v[210:211], v249 offset:37696
    v_mfma_f32_4x4x4_16b_bf16 v[100:103], v[98:99], v[214:215], v[100:103]
    s_waitcnt lgkmcnt(7)
    v_mfma_f32_32x32x16_bf16 v[144:159], v[216:219], v[192:195], v[144:159]
    v_mfma_f32_4x4x4_16b_bf16 v[104:107], v[98:99], v[216:217], v[104:107]
    ds_read_b64_tr_b16 v[212:213], v249 offset:36992
    ds_read_b64_tr_b16 v[214:215], v249 offset:37760
    v_mfma_f32_4x4x4_16b_bf16 v[104:107], v[98:99], v[218:219], v[104:107]
    s_waitcnt lgkmcnt(6)
    v_mfma_f32_32x32x16_bf16 v[160:175], v[220:223], v[192:195], v[160:175]
    v_mfma_f32_4x4x4_16b_bf16 v[108:111], v[98:99], v[220:221], v[108:111]
    ds_read_b64_tr_b16 v[216:217], v250 offset:36864
    ds_read_b64_tr_b16 v[218:219], v250 offset:37632
    v_mfma_f32_4x4x4_16b_bf16 v[108:111], v[98:99], v[222:223], v[108:111]
    s_add_u32 m0, s61, 16384
    s_add_u32 s77, s76, 5
    s_and_b32 s77, s77, 7
    s_lshl_b32 s77, s77, 7
    s_add_u32 s77, s77, s67
    s_add_u32 s63, s77, 0
    buffer_load_dwordx4 v12, s[40:43], s63 offen lds
    s_waitcnt lgkmcnt(6)
    v_mfma_f32_32x32x16_bf16 v[128:143], v[224:227], v[196:199], v[128:143]
    ds_read_b64_tr_b16 v[220:221], v250 offset:36928
    ds_read_b64_tr_b16 v[222:223], v250 offset:37696
    s_add_u32 m0, s61, 17408
    s_add_u32 s63, s77, 8192
    buffer_load_dwordx4 v13, s[40:43], s63 offen lds
    s_waitcnt lgkmcnt(6)
    v_mfma_f32_32x32x16_bf16 v[144:159], v[208:211], v[196:199], v[144:159]
    ds_read_b64_tr_b16 v[224:225], v250 offset:36992
    ds_read_b64_tr_b16 v[226:227], v250 offset:37760
    s_waitcnt lgkmcnt(6)
    v_mfma_f32_32x32x16_bf16 v[160:175], v[212:215], v[196:199], v[160:175]
    ds_read_b64_tr_b16 v[208:209], v251 offset:36864
    ds_read_b64_tr_b16 v[210:211], v251 offset:37632
    s_add_u32 m0, s61, 18432
    s_add_u32 s63, s77, 16384
    buffer_load_dwordx4 v12, s[40:43], s63 offen lds
    s_waitcnt lgkmcnt(6)
    v_mfma_f32_32x32x16_bf16 v[128:143], v[216:219], v[200:203], v[128:143]
    ds_read_b64_tr_b16 v[212:213], v251 offset:36928
    ds_read_b64_tr_b16 v[214:215], v251 offset:37696
    s_add_u32 m0, s61, 19456
    s_add_u32 s63, s77, 24576
    buffer_load_dwordx4 v13, s[40:43], s63 offen lds
    s_waitcnt lgkmcnt(6)
    v_mfma_f32_32x32x16_bf16 v[144:159], v[220:223], v[200:203], v[144:159]
    s_waitcnt vmcnt(7)
    s_barrier
    ds_read_b128 v[176:179], v244 offset:0
    ds_read_b64_tr_b16 v[216:217], v251 offset:36992
    ds_read_b64_tr_b16 v[218:219], v251 offset:37760
    s_add_u32 s78, s76, 6
    s_and_b32 s78, s78, 7
    s_mul_i32 s78, s78, 176128
    s_add_u32 s78, s78, s56
    s_add_u32 m0, s57, 24576
    s_nop 0
    buffer_load_dwordx4 v6, s[28:31], s78 offen lds
    s_waitcnt lgkmcnt(7)
    v_mfma_f32_32x32x16_bf16 v[160:175], v[224:227], v[200:203], v[160:175]
    ds_read_b128 v[180:183], v245 offset:0
    ds_read_b64_tr_b16 v[220:221], v248 offset:0
    ds_read_b64_tr_b16 v[222:223], v248 offset:768
    s_waitcnt lgkmcnt(8)
    v_mfma_f32_32x32x16_bf16 v[128:143], v[208:211], v[204:207], v[128:143]
    ds_read_b128 v[184:187], v246 offset:0
    ds_read_b64_tr_b16 v[224:225], v248 offset:64
    ds_read_b64_tr_b16 v[226:227], v248 offset:832
    s_add_u32 m0, s57, 25600
    s_nop 0
    buffer_load_dwordx4 v7, s[28:31], s78 offen lds
    s_waitcnt lgkmcnt(9)
    v_mfma_f32_32x32x16_bf16 v[144:159], v[212:215], v[204:207], v[144:159]
    ds_read_b128 v[188:191], v247 offset:0
    ds_read_b64_tr_b16 v[208:209], v248 offset:128
    ds_read_b64_tr_b16 v[210:211], v248 offset:896
    s_add_u32 m0, s57, 26624
    s_nop 0
    buffer_load_dwordx4 v8, s[28:31], s78 offen lds
    s_waitcnt lgkmcnt(9)
    v_mfma_f32_32x32x16_bf16 v[160:175], v[216:219], v[204:207], v[160:175]
    ds_read_b64_tr_b16 v[212:213], v249 offset:0
    ds_read_b64_tr_b16 v[214:215], v249 offset:768
    s_waitcnt lgkmcnt(8)
    v_mfma_f32_32x32x16_bf16 v[128:143], v[220:223], v[176:179], v[128:143]
    v_mfma_f32_4x4x4_16b_bf16 v[100:103], v[98:99], v[220:221], v[100:103]
    ds_read_b64_tr_b16 v[216:217], v249 offset:64
    ds_read_b64_tr_b16 v[218:219], v249 offset:832
    v_mfma_f32_4x4x4_16b_bf16 v[100:103], v[98:99], v[222:223], v[100:103]
    s_waitcnt lgkmcnt(7)
    v_mfma_f32_32x32x16_bf16 v[144:159], v[224:227], v[176:179], v[144:159]
    v_mfma_f32_4x4x4_16b_bf16 v[104:107], v[98:99], v[224:225], v[104:107]
    ds_read_b64_tr_b16 v[220:221], v249 offset:128
    ds_read_b64_tr_b16 v[222:223], v249 offset:896
    v_mfma_f32_4x4x4_16b_bf16 v[104:107], v[98:99], v[226:227], v[104:107]
    s_waitcnt lgkmcnt(6)
    v_mfma_f32_32x32x16_bf16 v[160:175], v[208:211], v[176:179], v[160:175]
    v_mfma_f32_4x4x4_16b_bf16 v[108:111], v[98:99], v[208:209], v[108:111]
    ds_read_b64_tr_b16 v[224:225], v250 offset:0
    ds_read_b64_tr_b16 v[226:227], v250 offset:768
    v_mfma_f32_4x4x4_16b_bf16 v[108:111], v[98:99], v[210:211], v[108:111]
    s_add_u32 m0, s61, 0
    s_add_u32 s77, s76, 6
    s_and_b32 s77, s77, 7
    s_lshl_b32 s77, s77, 7
    s_add_u32 s77, s77, s67
    s_add_u32 s63, s77, 0
    buffer_load_dwordx4 v12, s[40:43], s63 offen lds
    s_waitcnt lgkmcnt(6)
    v_mfma_f32_32x32x16_bf16 v[128:143], v[212:215], v[180:183], v[128:143]
    ds_read_b64_tr_b16 v[208:209], v250 offset:64
    ds_read_b64_tr_b16 v[210:211], v250 offset:832
    s_add_u32 m0, s61, 1024
    s_add_u32 s63, s77, 8192
    buffer_load_dwordx4 v13, s[40:43], s63 offen lds
    s_waitcnt lgkmcnt(6)
    v_mfma_f32_32x32x16_bf16 v[144:159], v[216:219], v[180:183], v[144:159]
    ds_read_b64_tr_b16 v[212:213], v250 offset:128
    ds_read_b64_tr_b16 v[214:215], v250 offset:896
    s_waitcnt lgkmcnt(6)
    v_mfma_f32_32x32x16_bf16 v[160:175], v[220:223], v[180:183], v[160:175]
    ds_read_b64_tr_b16 v[216:217], v251 offset:0
    ds_read_b64_tr_b16 v[218:219], v251 offset:768
    s_add_u32 m0, s61, 2048
    s_add_u32 s63, s77, 16384
    buffer_load_dwordx4 v12, s[40:43], s63 offen lds
    s_waitcnt lgkmcnt(6)
    v_mfma_f32_32x32x16_bf16 v[128:143], v[224:227], v[184:187], v[128:143]
    ds_read_b64_tr_b16 v[220:221], v251 offset:64
    ds_read_b64_tr_b16 v[222:223], v251 offset:832
    s_add_u32 m0, s61, 3072
    s_add_u32 s63, s77, 24576
    buffer_load_dwordx4 v13, s[40:43], s63 offen lds
    s_waitcnt lgkmcnt(6)
    v_mfma_f32_32x32x16_bf16 v[144:159], v[208:211], v[184:187], v[144:159]
    s_waitcnt vmcnt(7)
    s_barrier
    ds_read_b128 v[192:195], v244 offset:16384
    ds_read_b64_tr_b16 v[224:225], v251 offset:128
    ds_read_b64_tr_b16 v[226:227], v251 offset:896
    s_add_u32 s78, s76, 7
    s_and_b32 s78, s78, 7
    s_mul_i32 s78, s78, 176128
    s_add_u32 s78, s78, s56
    s_add_u32 m0, s57, 36864
    s_nop 0
    buffer_load_dwordx4 v6, s[28:31], s78 offen lds
    s_waitcnt lgkmcnt(7)
    v_mfma_f32_32x32x16_bf16 v[160:175], v[212:215], v[184:187], v[160:175]
    ds_read_b128 v[196:199], v245 offset:16384
    ds_read_b64_tr_b16 v[208:209], v248 offset:12288
    ds_read_b64_tr_b16 v[210:211], v248 offset:13056
    s_waitcnt lgkmcnt(8)
    v_mfma_f32_32x32x16_bf16 v[128:143], v[216:219], v[188:191], v[128:143]
    ds_read_b128 v[200:203], v246 offset:16384
    ds_read_b64_tr_b16 v[212:213], v248 offset:12352
    ds_read_b64_tr_b16 v[214:215], v248 offset:13120
    s_add_u32 m0, s57, 37888
    s_nop 0
    buffer_load_dwordx4 v7, s[28:31], s78 offen lds
    s_waitcnt lgkmcnt(9)
    v_mfma_f32_32x32x16_bf16 v[144:159], v[220:223], v[188:191], v[144:159]
    ds_read_b128 v[204:207], v247 offset:16384
    ds_read_b64_tr_b16 v[216:217], v248 offset:12416
    ds_read_b64_tr_b16 v[218:219], v248 offset:13184
    s_add_u32 m0, s57, 38912
    s_nop 0
    buffer_load_dwordx4 v8, s[28:31], s78 offen lds
    s_waitcnt lgkmcnt(9)
    v_mfma_f32_32x32x16_bf16 v[160:175], v[224:227], v[188:191], v[160:175]
    ds_read_b64_tr_b16 v[220:221], v249 offset:12288
    ds_read_b64_tr_b16 v[222:223], v249 offset:13056
    s_waitcnt lgkmcnt(8)
    v_mfma_f32_32x32x16_bf16 v[128:143], v[208:211], v[192:195], v[128:143]
    v_mfma_f32_4x4x4_16b_bf16 v[100:103], v[98:99], v[208:209], v[100:103]
    ds_read_b64_tr_b16 v[224:225], v249 offset:12352
    ds_read_b64_tr_b16 v[226:227], v249 offset:13120
    v_mfma_f32_4x4x4_16b_bf16 v[100:103], v[98:99], v[210:211], v[100:103]
    s_waitcnt lgkmcnt(7)
    v_mfma_f32_32x32x16_bf16 v[144:159], v[212:215], v[192:195], v[144:159]
    v_mfma_f32_4x4x4_16b_bf16 v[104:107], v[98:99], v[212:213], v[104:107]
    ds_read_b64_tr_b16 v[208:209], v249 offset:12416
    ds_read_b64_tr_b16 v[210:211], v249 offset:13184
    v_mfma_f32_4x4x4_16b_bf16 v[104:107], v[98:99], v[214:215], v[104:107]
    s_waitcnt lgkmcnt(6)
    v_mfma_f32_32x32x16_bf16 v[160:175], v[216:219], v[192:195], v[160:175]
    v_mfma_f32_4x4x4_16b_bf16 v[108:111], v[98:99], v[216:217], v[108:111]
    ds_read_b64_tr_b16 v[212:213], v250 offset:12288
    ds_read_b64_tr_b16 v[214:215], v250 offset:13056
    v_mfma_f32_4x4x4_16b_bf16 v[108:111], v[98:99], v[218:219], v[108:111]
    s_add_u32 m0, s61, 16384
    s_add_u32 s77, s76, 7
    s_and_b32 s77, s77, 7
    s_lshl_b32 s77, s77, 7
    s_add_u32 s77, s77, s67
    s_add_u32 s63, s77, 0
    buffer_load_dwordx4 v12, s[40:43], s63 offen lds
    s_waitcnt lgkmcnt(6)
    v_mfma_f32_32x32x16_bf16 v[128:143], v[220:223], v[196:199], v[128:143]
    ds_read_b64_tr_b16 v[216:217], v250 offset:12352
    ds_read_b64_tr_b16 v[218:219], v250 offset:13120
    s_add_u32 m0, s61, 17408
    s_add_u32 s63, s77, 8192
    buffer_load_dwordx4 v13, s[40:43], s63 offen lds
    s_waitcnt lgkmcnt(6)
    v_mfma_f32_32x32x16_bf16 v[144:159], v[224:227], v[196:199], v[144:159]
    ds_read_b64_tr_b16 v[220:221], v250 offset:12416
    ds_read_b64_tr_b16 v[222:223], v250 offset:13184
    s_waitcnt lgkmcnt(6)
    v_mfma_f32_32x32x16_bf16 v[160:175], v[208:211], v[196:199], v[160:175]
    ds_read_b64_tr_b16 v[224:225], v251 offset:12288
    ds_read_b64_tr_b16 v[226:227], v251 offset:13056
    s_add_u32 m0, s61, 18432
    s_add_u32 s63, s77, 16384
    buffer_load_dwordx4 v12, s[40:43], s63 offen lds
    s_waitcnt lgkmcnt(6)
    v_mfma_f32_32x32x16_bf16 v[128:143], v[212:215], v[200:203], v[128:143]
    ds_read_b64_tr_b16 v[208:209], v251 offset:12352
    ds_read_b64_tr_b16 v[210:211], v251 offset:13120
    s_add_u32 m0, s61, 19456
    s_add_u32 s63, s77, 24576
    buffer_load_dwordx4 v13, s[40:43], s63 offen lds
    s_waitcnt lgkmcnt(6)
    v_mfma_f32_32x32x16_bf16 v[144:159], v[216:219], v[200:203], v[144:159]
    s_waitcnt vmcnt(7)
    s_barrier
    ds_read_b128 v[176:179], v244 offset:0
    ds_read_b64_tr_b16 v[212:213], v251 offset:12416
    ds_read_b64_tr_b16 v[214:215], v251 offset:13184
    s_add_u32 s23, s79, 0
    s_cmp_ge_u32 s23, s48
    s_cselect_b32 s63, s48, 0
    s_sub_u32 s23, s23, s63
    s_lshl_b32 s23, s23, 14
    s_add_u32 s23, s23, s59
    s_add_u32 s63, s23, 0
    s_add_u32 m0, s57, 0
    s_nop 0
    buffer_load_dwordx4 v15, s[32:35], s63 offen lds
    s_waitcnt lgkmcnt(7)
    v_mfma_f32_32x32x16_bf16 v[160:175], v[220:223], v[200:203], v[160:175]
    ds_read_b128 v[180:183], v245 offset:0
    ds_read_b64_tr_b16 v[216:217], v248 offset:24576
    ds_read_b64_tr_b16 v[218:219], v248 offset:25344
    s_waitcnt lgkmcnt(8)
    v_mfma_f32_32x32x16_bf16 v[128:143], v[224:227], v[204:207], v[128:143]
    ds_read_b128 v[184:187], v246 offset:0
    ds_read_b64_tr_b16 v[220:221], v248 offset:24640
    ds_read_b64_tr_b16 v[222:223], v248 offset:25408
    s_add_u32 s63, s23, 8192
    s_add_u32 m0, s57, 1024
    s_nop 0
    buffer_load_dwordx4 v15, s[32:35], s63 offen lds
    s_waitcnt lgkmcnt(9)
    v_mfma_f32_32x32x16_bf16 v[144:159], v[208:211], v[204:207], v[144:159]
    ds_read_b128 v[188:191], v247 offset:0
    ds_read_b64_tr_b16 v[224:225], v248 offset:24704
    ds_read_b64_tr_b16 v[226:227], v248 offset:25472
    s_add_u32 s23, s79, 1
    s_cmp_ge_u32 s23, s48
    s_cselect_b32 s63, s48, 0
    s_sub_u32 s23, s23, s63
    s_lshl_b32 s23, s23, 14
    s_add_u32 s23, s23, s59
    s_add_u32 s63, s23, 0
    s_add_u32 m0, s57, 2048
    s_nop 0
    buffer_load_dwordx4 v15, s[32:35], s63 offen lds
    s_waitcnt lgkmcnt(9)
    v_mfma_f32_32x32x16_bf16 v[160:175], v[212:215], v[204:207], v[160:175]
    ds_read_b64_tr_b16 v[208:209], v249 offset:24576
    ds_read_b64_tr_b16 v[210:211], v249 offset:25344
    s_waitcnt lgkmcnt(8)
    v_mfma_f32_32x32x16_bf16 v[128:143], v[216:219], v[176:179], v[128:143]
    v_mfma_f32_4x4x4_16b_bf16 v[100:103], v[98:99], v[216:217], v[100:103]
    ds_read_b64_tr_b16 v[212:213], v249 offset:24640
    ds_read_b64_tr_b16 v[214:215], v249 offset:25408
    v_mfma_f32_4x4x4_16b_bf16 v[100:103], v[98:99], v[218:219], v[100:103]
    s_waitcnt lgkmcnt(7)
    v_mfma_f32_32x32x16_bf16 v[144:159], v[220:223], v[176:179], v[144:159]
    v_mfma_f32_4x4x4_16b_bf16 v[104:107], v[98:99], v[220:221], v[104:107]
    ds_read_b64_tr_b16 v[216:217], v249 offset:24704
    ds_read_b64_tr_b16 v[218:219], v249 offset:25472
    v_mfma_f32_4x4x4_16b_bf16 v[104:107], v[98:99], v[222:223], v[104:107]
    s_waitcnt lgkmcnt(6)
    v_mfma_f32_32x32x16_bf16 v[160:175], v[224:227], v[176:179], v[160:175]
    v_mfma_f32_4x4x4_16b_bf16 v[108:111], v[98:99], v[224:225], v[108:111]
    ds_read_b64_tr_b16 v[220:221], v250 offset:24576
    ds_read_b64_tr_b16 v[222:223], v250 offset:25344
    v_mfma_f32_4x4x4_16b_bf16 v[108:111], v[98:99], v[226:227], v[108:111]
    s_add_u32 s63, s23, 8192
    s_add_u32 m0, s61, 1024
    s_nop 0
    buffer_load_dwordx4 v15, s[32:35], s63 offen lds
    s_waitcnt lgkmcnt(6)
    v_mfma_f32_32x32x16_bf16 v[128:143], v[208:211], v[180:183], v[128:143]
    ds_read_b64_tr_b16 v[224:225], v250 offset:24640
    ds_read_b64_tr_b16 v[226:227], v250 offset:25408
    s_add_u32 s23, s79, 2
    s_cmp_ge_u32 s23, s48
    s_cselect_b32 s63, s48, 0
    s_sub_u32 s23, s23, s63
    s_lshl_b32 s23, s23, 14
    s_add_u32 s23, s23, s59
    s_add_u32 s63, s23, 0
    s_add_u32 m0, s61, 2048
    s_nop 0
    buffer_load_dwordx4 v15, s[32:35], s63 offen lds
    s_waitcnt lgkmcnt(6)
    v_mfma_f32_32x32x16_bf16 v[144:159], v[212:215], v[180:183], v[144:159]
    ds_read_b64_tr_b16 v[208:209], v250 offset:24704
    ds_read_b64_tr_b16 v[210:211], v250 offset:25472
    global_load_dword v14, v10, s[18:19] sc1
    buffer_load_dwordx4 v[236:239], v3, s[24:27], s74 offen sc1
    s_waitcnt lgkmcnt(6)
    v_mfma_f32_32x32x16_bf16 v[160:175], v[216:219], v[180:183], v[160:175]
    ds_read_b64_tr_b16 v[212:213], v251 offset:24576
    ds_read_b64_tr_b16 v[214:215], v251 offset:25344
    s_add_u32 s63, s23, 8192
    s_add_u32 m0, s61, 3072
    s_nop 0
    buffer_load_dwordx4 v15, s[32:35], s63 offen lds
    s_waitcnt lgkmcnt(6)
    v_mfma_f32_32x32x16_bf16 v[128:143], v[220:223], v[184:187], v[128:143]
    ds_read_b64_tr_b16 v[216:217], v251 offset:24640
    ds_read_b64_tr_b16 v[218:219], v251 offset:25408
    s_waitcnt lgkmcnt(6)
    v_mfma_f32_32x32x16_bf16 v[144:159], v[224:227], v[184:187], v[144:159]
    s_waitcnt vmcnt(8)
    s_barrier
    ds_read_b128 v[192:195], v244 offset:16384
    ds_read_b64_tr_b16 v[220:221], v251 offset:24704
    ds_read_b64_tr_b16 v[222:223], v251 offset:25472
    s_add_u32 s23, s79, 3
    s_cmp_ge_u32 s23, s48
    s_cselect_b32 s63, s48, 0
    s_sub_u32 s23, s23, s63
    s_lshl_b32 s23, s23, 14
    s_add_u32 s23, s23, s59
    s_add_u32 s63, s23, 0
    s_add_u32 m0, s57, 12288
    s_nop 0
    buffer_load_dwordx4 v15, s[32:35], s63 offen lds
    ds_read_b64_tr_b16 v[112:113], v248 offset:36864
    ds_read_b64_tr_b16 v[114:115], v248 offset:37632
    ds_read_b64_tr_b16 v[116:117], v248 offset:36928
    ds_read_b64_tr_b16 v[118:119], v248 offset:37696
    ds_read_b64_tr_b16 v[120:121], v248 offset:36992
    ds_read_b64_tr_b16 v[122:123], v248 offset:37760
    s_waitcnt lgkmcnt(13)
    v_mfma_f32_32x32x16_bf16 v[160:175], v[208:211], v[184:187], v[160:175]
    ds_read_b128 v[196:199], v245 offset:16384
    ds_read_b64_tr_b16 v[224:225], v248 offset:36864
    ds_read_b64_tr_b16 v[226:227], v248 offset:37632
    s_waitcnt lgkmcnt(14)
    v_mfma_f32_32x32x16_bf16 v[128:143], v[212:215], v[188:191], v[128:143]
    ds_read_b128 v[200:203], v246 offset:16384
    ds_read_b64_tr_b16 v[208:209], v249 offset:36864
    ds_read_b64_tr_b16 v[210:211], v249 offset:37632
    s_add_u32 s63, s23, 8192
    s_add_u32 m0, s57, 13312
    s_nop 0
    buffer_load_dwordx4 v15, s[32:35], s63 offen lds
    s_waitcnt lgkmcnt(15)
    v_mfma_f32_32x32x16_bf16 v[144:159], v[216:219], v[188:191], v[144:159]
    ds_read_b128 v[204:207], v247 offset:16384
    ds_read_b64_tr_b16 v[212:213], v250 offset:36864
    ds_read_b64_tr_b16 v[214:215], v250 offset:37632
    s_add_u32 s23, s79, 4
    s_cmp_ge_u32 s23, s48
    s_cselect_b32 s63, s48, 0
    s_sub_u32 s23, s23, s63
    s_lshl_b32 s23, s23, 14
    s_add_u32 s23, s23, s59
    s_add_u32 s63, s23, 0
    s_add_u32 m0, s57, 14336
    s_nop 0
    buffer_load_dwordx4 v15, s[32:35], s63 offen lds
    s_waitcnt lgkmcnt(9)
    v_mfma_f32_4x4x4_16b_bf16 v[100:103], v[98:99], v[112:113], v[100:103]
    v_mfma_f32_4x4x4_16b_bf16 v[104:107], v[98:99], v[116:117], v[104:107]
    v_mfma_f32_4x4x4_16b_bf16 v[108:111], v[98:99], v[120:121], v[108:111]
    v_mfma_f32_4x4x4_16b_bf16 v[100:103], v[98:99], v[114:115], v[100:103]
    v_mfma_f32_4x4x4_16b_bf16 v[104:107], v[98:99], v[118:119], v[104:107]
    v_mfma_f32_4x4x4_16b_bf16 v[108:111], v[98:99], v[122:123], v[108:111]
    s_waitcnt lgkmcnt(15)
    v_mfma_f32_32x32x16_bf16 v[160:175], v[220:223], v[188:191], v[160:175]
    ds_read_b64_tr_b16 v[216:217], v251 offset:36864
    ds_read_b64_tr_b16 v[218:219], v251 offset:37632
    v_lshl_add_u32 v240, v1, 2, s61
    v_lshlrev_b32_e64 v241, 2, v1
    ds_write_b32 v240, v100 offset:0
    ds_write_b32 v240, v104 offset:256
    ds_write_b32 v240, v108 offset:512
    s_waitcnt vmcnt(9)
    ds_read_b64_tr_b16 v[16:17], v252 offset:0
    ds_read_b64_tr_b16 v[18:19], v252 offset:1024
    ds_read_b64_tr_b16 v[20:21], v253 offset:0
    ds_read_b64_tr_b16 v[22:23], v253 offset:1024
    s_waitcnt lgkmcnt(15)
    v_mfma_f32_32x32x16_bf16 v[128:143], v[224:227], v[192:195], v[128:143]
    ds_read_b64_tr_b16 v[220:221], v248 offset:36928
    ds_read_b64_tr_b16 v[222:223], v248 offset:37696
    s_waitcnt lgkmcnt(6)
    s_barrier
    ds_read_b32 v112, v241 offset:49152
    ds_read_b32 v113, v241 offset:53248
    ds_read_b32 v114, v241 offset:57344
    ds_read_b32 v115, v241 offset:61440
    ds_read_b32 v116, v241 offset:49408
    ds_read_b32 v117, v241 offset:53504
    ds_read_b32 v118, v241 offset:57600
    ds_read_b32 v119, v241 offset:61696
    ds_read_b32 v120, v241 offset:49664
    ds_read_b32 v121, v241 offset:53760
    ds_read_b32 v122, v241 offset:57856
    ds_read_b32 v123, v241 offset:61952
    s_waitcnt lgkmcnt(15)
    v_mfma_f32_32x32x16_bf16 v[128:143], v[208:211], v[196:199], v[128:143]
    ds_read_b64_tr_b16 v[224:225], v249 offset:36928
    ds_read_b64_tr_b16 v[226:227], v249 offset:37696
    s_waitcnt vmcnt(4)
    s_mov_b32 s70, 262144
L_M_tag:
    v_cmp_eq_u32_e64 vcc, 0, v14
    s_cbranch_vccz L_M_tag_ok
    s_sub_u32 s70, s70, 1
    s_cbranch_scc1 L_M_tag_ok
    s_sleep 2
    global_load_dword v14, v10, s[18:19] sc1
    s_waitcnt vmcnt(0)
    s_branch L_M_tag
L_M_tag_ok:
    s_mov_b32 s70, 262144
    s_waitcnt vmcnt(4)
L_M_st:
    v_cmp_ne_u32 vcc, v239, v14
    s_cbranch_vccz L_M_st_ok
    s_sub_u32 s70, s70, 1
    s_cbranch_scc1 L_M_st_ok
    s_sleep 2
    buffer_load_dwordx4 v[236:239], v3, s[24:27], s74 offen sc1
    s_waitcnt vmcnt(0)
    s_branch L_M_st
L_M_st_ok:
    v_cmp_gt_u32 vcc, 32, v1
    s_nop 1
    v_cndmask_b32_e64 v238, 0, v238, vcc
    v_cvt_pk_bf16_f32 v76, -v236, -v236
    v_cvt_pk_bf16_f32 v77, -v236, v238
    s_waitcnt lgkmcnt(15)
    v_mfma_f32_32x32x16_bf16 v[128:143], v[212:215], v[200:203], v[128:143]
    ds_read_b64_tr_b16 v[208:209], v250 offset:36928
    ds_read_b64_tr_b16 v[210:211], v250 offset:37696
    s_add_u32 s63, s23, 8192
    s_add_u32 m0, s61, 16384
    s_nop 0
    buffer_load_dwordx4 v15, s[32:35], s63 offen lds
    s_waitcnt lgkmcnt(4)
    v_add_f32 v112, v112, v113
    v_add_f32 v114, v114, v115
    v_add_f32 v112, v112, v114
    v_cvt_pk_bf16_f32 v113, 0, v112
    v_sub_f32_e64 v112, v112, v113
    v_cvt_pk_bf16_f32 v114, 0, v112
    v_sub_f32_e64 v112, v112, v114
    v_cvt_pk_bf16_f32 v64, v113, v114
    v_cvt_pk_bf16_f32 v65, v112, 0
    v_lshl_or_b32 v65, v231, 16, v65
    s_waitcnt vmcnt(4)
    ds_read_b64_tr_b16 v[24:25], v252 offset:2048
    ds_read_b64_tr_b16 v[26:27], v254 offset:1024
    ds_read_b64_tr_b16 v[28:29], v253 offset:2048
    ds_read_b64_tr_b16 v[30:31], v255 offset:1024
    ds_read_b64_tr_b16 v[32:33], v254 offset:2048
    ds_read_b64_tr_b16 v[34:35], v254 offset:3072
    ds_read_b64_tr_b16 v[36:37], v255 offset:2048
    ds_read_b64_tr_b16 v[38:39], v255 offset:3072
    s_waitcnt lgkmcnt(15)
    v_mfma_f32_32x32x16_bf16 v[128:143], v[216:219], v[204:207], v[128:143]
    ds_read_b64_tr_b16 v[212:213], v251 offset:36928
    ds_read_b64_tr_b16 v[214:215], v251 offset:37696
    s_add_u32 s23, s79, 5
    s_cmp_ge_u32 s23, s48
    s_cselect_b32 s63, s48, 0
    s_sub_u32 s23, s23, s63
    s_lshl_b32 s23, s23, 14
    s_add_u32 s23, s23, s59
    s_add_u32 s63, s23, 0
    s_add_u32 m0, s61, 17408
    s_nop 0
    buffer_load_dwordx4 v15, s[32:35], s63 offen lds
    v_add_f32 v116, v116, v117
    v_add_f32 v118, v118, v119
    v_add_f32_e64 v116, v116, v118
    v_cvt_pk_bf16_f32 v117, 0, v116
    v_sub_f32_e64 v116, v116, v117
    v_cvt_pk_bf16_f32 v118, 0, v116
    v_sub_f32_e64 v116, v116, v118
    v_cvt_pk_bf16_f32 v68, v117, v118
    v_cvt_pk_bf16_f32 v69, v116, 0
    v_lshl_or_b32 v69, v232, 16, v69
    v_mfma_f32_32x32x16_bf16 v[128:143], v[64:67], v[76:79], v[128:143]
    s_waitcnt lgkmcnt(15)
    v_mfma_f32_32x32x16_bf16 v[144:159], v[220:223], v[192:195], v[144:159]
    ds_read_b64_tr_b16 v[216:217], v248 offset:36992
    ds_read_b64_tr_b16 v[218:219], v248 offset:37760
    s_add_u32 s63, s23, 8192
    s_add_u32 m0, s61, 18432
    s_nop 0
    buffer_load_dwordx4 v15, s[32:35], s63 offen lds
    v_add_f32 v120, v120, v121
    v_add_f32 v122, v122, v123
    v_add_f32_e64 v120, v120, v122
    v_cvt_pk_bf16_f32 v121, 0, v120
    v_sub_f32_e64 v120, v120, v121
    v_cvt_pk_bf16_f32 v122, 0, v120
    v_sub_f32_e64 v120, v120, v122
    v_cvt_pk_bf16_f32 v72, v121, v122
    v_cvt_pk_bf16_f32 v73, v120, 0
    v_lshl_or_b32 v73, v233, 16, v73
    s_waitcnt lgkmcnt(14)
    v_mfma_f32_32x32x16_bf16 v[144:159], v[224:227], v[196:199], v[144:159]
    ds_read_b64_tr_b16 v[220:221], v249 offset:36992
    ds_read_b64_tr_b16 v[222:223], v249 offset:37760
    s_add_u32 s23, s79, 6
    s_cmp_ge_u32 s23, s48
    s_cselect_b32 s63, s48, 0
    s_sub_u32 s23, s23, s63
    s_lshl_b32 s23, s23, 14
    s_add_u32 s23, s23, s59
    s_add_u32 s63, s23, 0
    s_add_u32 m0, s61, 19456
    s_nop 0
    buffer_load_dwordx4 v15, s[32:35], s63 offen lds
    v_max_f32 v128, 0, v128
    v_mul_f32 v128, v128, v128
    v_max_f32 v129, 0, v129
    v_mul_f32_e64 v129, v129, v129
    v_cvt_pk_bf16_f32 v128, v128, v129
    v_max_f32 v130, 0, v130
    v_mul_f32 v130, v130, v130
    v_max_f32 v131, 0, v131
    v_mul_f32 v131, v131, v131
    v_cvt_pk_bf16_f32 v129, v130, v131
    v_max_f32 v132, 0, v132
    s_waitcnt lgkmcnt(14)
    v_mfma_f32_32x32x16_bf16 v[144:159], v[208:211], v[200:203], v[144:159]
    ds_read_b64_tr_b16 v[224:225], v250 offset:36992
    ds_read_b64_tr_b16 v[226:227], v250 offset:37760
    s_add_u32 s63, s23, 8192
    s_add_u32 m0, s57, 24576
    s_nop 0
    buffer_load_dwordx4 v15, s[32:35], s63 offen lds
    v_mul_f32 v132, v132, v132
    v_max_f32 v133, 0, v133
    v_mul_f32 v133, v133, v133
    v_cvt_pk_bf16_f32 v130, v132, v133
    v_max_f32 v134, 0, v134
    v_mul_f32 v134, v134, v134
    v_max_f32 v135, 0, v135
    v_mul_f32 v135, v135, v135
    v_cvt_pk_bf16_f32 v131, v134, v135
    buffer_store_dwordx4 v[128:131], v2, s[24:27], s68 offen offset:0 sc1
    v_max_f32 v136, 0, v136
    s_waitcnt lgkmcnt(6)
    v_mfma_f32_32x32x16_bf16 v[144:159], v[212:215], v[204:207], v[144:159]
    ds_read_b64_tr_b16 v[208:209], v251 offset:36992
    ds_read_b64_tr_b16 v[210:211], v251 offset:37760
    s_add_u32 s23, s79, 7
    s_cmp_ge_u32 s23, s48
    s_cselect_b32 s63, s48, 0
    s_sub_u32 s23, s23, s63
    s_lshl_b32 s23, s23, 14
    s_add_u32 s23, s23, s59
    s_add_u32 s63, s23, 0
    s_add_u32 m0, s57, 25600
    s_nop 0
    buffer_load_dwordx4 v15, s[32:35], s63 offen lds
    v_mfma_f32_32x32x16_bf16 v[144:159], v[68:71], v[76:79], v[144:159]
    v_mul_f32 v136, v136, v136
    v_max_f32 v137, 0, v137
    v_mul_f32_e64 v137, v137, v137
    v_cvt_pk_bf16_f32 v132, v136, v137
    v_max_f32 v138, 0, v138
    v_mul_f32 v138, v138, v138
    v_max_f32 v139, 0, v139
    v_mul_f32 v139, v139, v139
    v_cvt_pk_bf16_f32 v133, v138, v139
    v_max_f32 v140, 0, v140
    v_mul_f32_e64 v140, v140, v140
    s_waitcnt lgkmcnt(6)
    v_mfma_f32_32x32x16_bf16 v[160:175], v[216:219], v[192:195], v[160:175]
    s_add_u32 s63, s23, 8192
    s_add_u32 m0, s57, 26624
    s_nop 0
    buffer_load_dwordx4 v15, s[32:35], s63 offen lds
    v_max_f32 v141, 0, v141
    v_mul_f32_e64 v141, v141, v141
    v_cvt_pk_bf16_f32 v134, v140, v141
    v_max_f32 v142, 0, v142
    v_mul_f32 v142, v142, v142
    v_max_f32 v143, 0, v143
    v_mul_f32 v143, v143, v143
    v_cvt_pk_bf16_f32 v135, v142, v143
    buffer_store_dwordx4 v[132:135], v2, s[24:27], s68 offen offset:1024 sc1
    s_waitcnt lgkmcnt(4)
    v_mfma_f32_32x32x16_bf16 v[160:175], v[220:223], v[196:199], v[160:175]
    s_waitcnt lgkmcnt(10)
    s_add_u32 s23, s79, 8
    s_cmp_ge_u32 s23, s48
    s_cselect_b32 s63, s48, 0
    s_sub_u32 s23, s23, s63
    s_lshl_b32 s23, s23, 14
    s_add_u32 s23, s23, s59
    s_add_u32 s63, s23, 0
    s_add_u32 m0, s57, 0
    s_nop 0
    buffer_load_dwordx4 v15, s[32:35], s63 offen lds
    s_add_u32 s63, s23, 8192
    s_add_u32 m0, s57, 1024
    s_nop 0
    buffer_load_dwordx4 v15, s[32:35], s63 offen lds
    v_max_f32 v144, 0, v144
    v_mul_f32 v144, v144, v144
    v_max_f32 v145, 0, v145
    v_mul_f32 v145, v145, v145
    v_cvt_pk_bf16_f32 v144, v144, v145
    v_max_f32 v146, 0, v146
    v_mul_f32 v146, v146, v146
    v_max_f32 v147, 0, v147
    v_mul_f32 v147, v147, v147
    v_cvt_pk_bf16_f32 v145, v146, v147
    v_max_f32 v148, 0, v148
    s_waitcnt lgkmcnt(2)
    v_mfma_f32_32x32x16_bf16 v[160:175], v[224:227], v[200:203], v[160:175]
    s_add_u32 s23, s79, 9
    s_cmp_ge_u32 s23, s48
    s_cselect_b32 s63, s48, 0
    s_sub_u32 s23, s23, s63
    s_lshl_b32 s23, s23, 14
    s_add_u32 s23, s23, s59
    s_add_u32 s63, s23, 0
    s_add_u32 m0, s57, 2048
    s_nop 0
    buffer_load_dwordx4 v15, s[32:35], s63 offen lds
    s_add_u32 s63, s23, 8192
    s_add_u32 m0, s61, 1024
    s_nop 0
    buffer_load_dwordx4 v15, s[32:35], s63 offen lds
    v_mul_f32 v148, v148, v148
    v_max_f32 v149, 0, v149
    v_mul_f32 v149, v149, v149
    v_cvt_pk_bf16_f32 v146, v148, v149
    v_max_f32 v150, 0, v150
    v_mul_f32 v150, v150, v150
    v_max_f32 v151, 0, v151
    v_mul_f32 v151, v151, v151
    v_cvt_pk_bf16_f32 v147, v150, v151
    buffer_store_dwordx4 v[144:147], v2, s[24:27], s73 offen offset:2048 sc1
    v_max_f32 v152, 0, v152
    s_waitcnt lgkmcnt(0)
    v_mfma_f32_32x32x16_bf16 v[160:175], v[208:211], v[204:207], v[160:175]
    v_mfma_f32_32x32x16_bf16 v[160:175], v[72:75], v[76:79], v[160:175]
    s_add_u32 s23, s79, 10
    s_cmp_ge_u32 s23, s48
    s_cselect_b32 s63, s48, 0
    s_sub_u32 s23, s23, s63
    s_lshl_b32 s23, s23, 14
    s_add_u32 s23, s23, s59
    s_add_u32 s63, s23, 0
    s_add_u32 m0, s61, 2048
    s_nop 0
    buffer_load_dwordx4 v15, s[32:35], s63 offen lds
    s_add_u32 s63, s23, 8192
    s_add_u32 m0, s61, 3072
    s_nop 0
    buffer_load_dwordx4 v15, s[32:35], s63 offen lds
    v_mul_f32 v152, v152, v152
    v_max_f32 v153, 0, v153
    v_mul_f32 v153, v153, v153
    v_cvt_pk_bf16_f32 v148, v152, v153
    v_max_f32 v154, 0, v154
    v_mul_f32 v154, v154, v154
    v_max_f32 v155, 0, v155
    v_mul_f32 v155, v155, v155
    v_cvt_pk_bf16_f32 v149, v154, v155
    v_max_f32 v156, 0, v156
    v_mul_f32_e64 v156, v156, v156
    s_waitcnt vmcnt(15)
    ds_read_b64_tr_b16 v[40:41], v252 offset:12288
    ds_read_b64_tr_b16 v[42:43], v252 offset:13312
    ds_read_b64_tr_b16 v[44:45], v253 offset:12288
    ds_read_b64_tr_b16 v[46:47], v253 offset:13312
    ds_read_b64_tr_b16 v[48:49], v252 offset:14336
    ds_read_b64_tr_b16 v[50:51], v254 offset:16384
    ds_read_b64_tr_b16 v[52:53], v253 offset:14336
    ds_read_b64_tr_b16 v[54:55], v255 offset:16384
    v_max_f32 v157, 0, v157
    v_mul_f32 v157, v157, v157
    v_cvt_pk_bf16_f32 v150, v156, v157
    v_max_f32 v158, 0, v158
    v_mul_f32 v158, v158, v158
    v_max_f32 v159, 0, v159
    v_mul_f32 v159, v159, v159
    v_cvt_pk_bf16_f32 v151, v158, v159
    buffer_store_dwordx4 v[148:151], v2, s[24:27], s73 offen offset:3072 sc1
    v_max_f32 v160, 0, v160
    v_max_f32 v161, 0, v161
    v_pk_mul_f32 v[160:161], v[160:161], v[160:161]
    v_cvt_pk_bf16_f32 v160, v160, v161
    v_max_f32 v162, 0, v162
    v_max_f32 v163, 0, v163
    v_pk_mul_f32 v[162:163], v[162:163], v[162:163]
    v_cvt_pk_bf16_f32 v161, v162, v163
    v_max_f32 v164, 0, v164
    v_max_f32 v165, 0, v165
    v_pk_mul_f32 v[164:165], v[164:165], v[164:165]
    v_cvt_pk_bf16_f32 v162, v164, v165
    v_max_f32 v166, 0, v166
    v_max_f32 v167, 0, v167
    v_pk_mul_f32 v[166:167], v[166:167], v[166:167]
    v_cvt_pk_bf16_f32 v163, v166, v167
    buffer_store_dwordx4 v[160:163], v2, s[24:27], s66 offen offset:0 sc1
    v_max_f32 v168, 0, v168
    v_max_f32 v169, 0, v169
    v_pk_mul_f32 v[168:169], v[168:169], v[168:169]
    v_cvt_pk_bf16_f32 v164, v168, v169
    v_max_f32 v170, 0, v170
    v_max_f32 v171, 0, v171
    v_pk_mul_f32 v[170:171], v[170:171], v[170:171]
    v_cvt_pk_bf16_f32 v165, v170, v171
    v_max_f32 v172, 0, v172
    v_max_f32 v173, 0, v173
    v_pk_mul_f32 v[172:173], v[172:173], v[172:173]
    v_cvt_pk_bf16_f32 v166, v172, v173
    v_max_f32 v174, 0, v174
    v_max_f32 v175, 0, v175
    v_pk_mul_f32 v[174:175], v[174:175], v[174:175]
    v_cvt_pk_bf16_f32 v167, v174, v175
    buffer_store_dwordx4 v[164:167], v2, s[24:27], s66 offen offset:1024 sc1
    s_waitcnt lgkmcnt(0)
    s_add_u32 s23, s79, 13
    s_cmp_ge_u32 s23, s48
    s_cselect_b32 s63, s48, 0
    s_sub_u32 s23, s23, s63
    s_lshl_b32 s23, s23, 14
    s_add_u32 s23, s23, s59
    s_add_u32 s63, s23, 0
    s_add_u32 m0, s57, 12288
    s_nop 0
    buffer_load_dwordx4 v15, s[32:35], s63 offen lds
    s_add_u32 s63, s23, 8192
    s_add_u32 m0, s57, 13312
    s_nop 0
    buffer_load_dwordx4 v15, s[32:35], s63 offen lds
    s_add_u32 s23, s79, 14
    s_cmp_ge_u32 s23, s48
    s_cselect_b32 s63, s48, 0
    s_sub_u32 s23, s23, s63
    s_lshl_b32 s23, s23, 14
    s_add_u32 s23, s23, s59
    s_add_u32 s63, s23, 0
    s_add_u32 m0, s57, 14336
    s_nop 0
    buffer_load_dwordx4 v15, s[32:35], s63 offen lds
    s_add_u32 s63, s23, 8192
    s_add_u32 m0, s61, 16384
    s_nop 0
    buffer_load_dwordx4 v15, s[32:35], s63 offen lds
    s_waitcnt vmcnt(4)
    s_barrier
    s_cmp_lg_u32 s22, 0
    s_cbranch_scc1 L_M_nf2
    s_lshl_b32 s71, s49, 11
    s_lshl_b32 s72, s50, 7
    s_add_u32 s71, s71, s72
    s_add_u32 s71, s71, 0xc10000
    s_mov_b64 exec, 1
    buffer_store_dword v14, v10, s[24:27], s71 offen sc1
    s_mov_b64 exec, -1
L_M_nf2:
    ds_read_b64_tr_b16 v[56:57], v254 offset:17408
    ds_read_b64_tr_b16 v[58:59], v254 offset:18432
    ds_read_b64_tr_b16 v[60:61], v255 offset:17408
    ds_read_b64_tr_b16 v[62:63], v255 offset:18432
    ds_read_b64_tr_b16 v[64:65], v254 offset:19456
    ds_read_b64_tr_b16 v[66:67], v252 offset:24576
    ds_read_b64_tr_b16 v[68:69], v255 offset:19456
    ds_read_b64_tr_b16 v[70:71], v253 offset:24576
    ds_read_b64_tr_b16 v[72:73], v252 offset:25600
    ds_read_b64_tr_b16 v[74:75], v252 offset:26624
    ds_read_b64_tr_b16 v[76:77], v253 offset:25600
    ds_read_b64_tr_b16 v[78:79], v253 offset:26624
    ds_read_b64_tr_b16 v[80:81], v252 offset:0
    ds_read_b64_tr_b16 v[82:83], v252 offset:1024
    ds_read_b64_tr_b16 v[84:85], v253 offset:0
    ds_read_b64_tr_b16 v[86:87], v253 offset:1024
    ds_read_b64_tr_b16 v[88:89], v252 offset:2048
    ds_read_b64_tr_b16 v[90:91], v254 offset:1024
    ds_read_b64_tr_b16 v[92:93], v253 offset:2048
    ds_read_b64_tr_b16 v[94:95], v255 offset:1024
    ds_read_b64_tr_b16 v[96:97], v254 offset:2048
    ds_read_b64_tr_b16 v[98:99], v254 offset:3072
    ds_read_b64_tr_b16 v[100:101], v255 offset:2048
    ds_read_b64_tr_b16 v[102:103], v255 offset:3072
    s_branch L_M_join
L_M_g15:
    s_add_u32 s23, s79, 0
    s_cmp_ge_u32 s23, s48
    s_cselect_b32 s63, s48, 0
    s_sub_u32 s23, s23, s63
    s_lshl_b32 s23, s23, 14
    s_add_u32 s23, s23, s59
    s_add_u32 s63, s23, 0
    s_add_u32 m0, s57, 0
    s_nop 0
    buffer_load_dwordx4 v15, s[32:35], s63 offen lds
    s_add_u32 s63, s23, 8192
    s_add_u32 m0, s57, 1024
    s_nop 0
    buffer_load_dwordx4 v15, s[32:35], s63 offen lds
    s_add_u32 s23, s79, 1
    s_cmp_ge_u32 s23, s48
    s_cselect_b32 s63, s48, 0
    s_sub_u32 s23, s23, s63
    s_lshl_b32 s23, s23, 14
    s_add_u32 s23, s23, s59
    s_add_u32 s63, s23, 0
    s_add_u32 m0, s57, 2048
    s_nop 0
    buffer_load_dwordx4 v15, s[32:35], s63 offen lds
    s_add_u32 s63, s23, 8192
    s_add_u32 m0, s61, 1024
    s_nop 0
    buffer_load_dwordx4 v15, s[32:35], s63 offen lds
    s_add_u32 s23, s79, 2
    s_cmp_ge_u32 s23, s48
    s_cselect_b32 s63, s48, 0
    s_sub_u32 s23, s23, s63
    s_lshl_b32 s23, s23, 14
    s_add_u32 s23, s23, s59
    s_add_u32 s63, s23, 0
    s_add_u32 m0, s61, 2048
    s_nop 0
    buffer_load_dwordx4 v15, s[32:35], s63 offen lds
    s_add_u32 s63, s23, 8192
    s_add_u32 m0, s61, 3072
    s_nop 0
    buffer_load_dwordx4 v15, s[32:35], s63 offen lds
    s_add_u32 s23, s79, 3
    s_cmp_ge_u32 s23, s48
    s_cselect_b32 s63, s48, 0
    s_sub_u32 s23, s23, s63
    s_lshl_b32 s23, s23, 14
    s_add_u32 s23, s23, s59
    s_add_u32 s63, s23, 0
    s_add_u32 m0, s57, 12288
    s_nop 0
    buffer_load_dwordx4 v15, s[32:35], s63 offen lds
    s_add_u32 s63, s23, 8192
    s_add_u32 m0, s57, 13312
    s_nop 0
    buffer_load_dwordx4 v15, s[32:35], s63 offen lds
    s_add_u32 s23, s79, 4
    s_cmp_ge_u32 s23, s48
    s_cselect_b32 s63, s48, 0
    s_sub_u32 s23, s23, s63
    s_lshl_b32 s23, s23, 14
    s_add_u32 s23, s23, s59
    s_add_u32 s63, s23, 0
    s_add_u32 m0, s57, 14336
    s_nop 0
    buffer_load_dwordx4 v15, s[32:35], s63 offen lds
    s_add_u32 s63, s23, 8192
    s_add_u32 m0, s61, 16384
    s_nop 0
    buffer_load_dwordx4 v15, s[32:35], s63 offen lds
    s_add_u32 s23, s79, 5
    s_cmp_ge_u32 s23, s48
    s_cselect_b32 s63, s48, 0
    s_sub_u32 s23, s23, s63
    s_lshl_b32 s23, s23, 14
    s_add_u32 s23, s23, s59
    s_add_u32 s63, s23, 0
    s_add_u32 m0, s61, 17408
    s_nop 0
    buffer_load_dwordx4 v15, s[32:35], s63 offen lds
    s_add_u32 s63, s23, 8192
    s_add_u32 m0, s61, 18432
    s_nop 0
    buffer_load_dwordx4 v15, s[32:35], s63 offen lds
    s_add_u32 s23, s79, 6
    s_cmp_ge_u32 s23, s48
    s_cselect_b32 s63, s48, 0
    s_sub_u32 s23, s23, s63
    s_lshl_b32 s23, s23, 14
    s_add_u32 s23, s23, s59
    s_add_u32 s63, s23, 0
    s_add_u32 m0, s61, 19456
    s_nop 0
    buffer_load_dwordx4 v15, s[32:35], s63 offen lds
    s_add_u32 s63, s23, 8192
    s_add_u32 m0, s57, 24576
    s_nop 0
    buffer_load_dwordx4 v15, s[32:35], s63 offen lds
    s_add_u32 s23, s79, 7
    s_cmp_ge_u32 s23, s48
    s_cselect_b32 s63, s48, 0
    s_sub_u32 s23, s23, s63
    s_lshl_b32 s23, s23, 14
    s_add_u32 s23, s23, s59
    s_add_u32 s63, s23, 0
    s_add_u32 m0, s57, 25600
    s_nop 0
    buffer_load_dwordx4 v15, s[32:35], s63 offen lds
    s_add_u32 s63, s23, 8192
    s_add_u32 m0, s57, 26624
    s_nop 0
    buffer_load_dwordx4 v15, s[32:35], s63 offen lds
    global_load_dword v14, v10, s[18:19] sc1
    s_waitcnt vmcnt(0)
    s_mov_b32 s70, 262144
L_M_tag15:
    v_cmp_eq_u32 vcc, 0, v14
    s_cbranch_vccz L_M_tag15_ok
    s_sub_u32 s70, s70, 1
    s_cbranch_scc1 L_M_tag15_ok
    s_sleep 2
    global_load_dword v14, v10, s[18:19] sc1
    s_waitcnt vmcnt(0)
    s_branch L_M_tag15
L_M_tag15_ok:
    ds_read_b64_tr_b16 v[16:17], v252 offset:0
    ds_read_b64_tr_b16 v[18:19], v252 offset:1024
    ds_read_b64_tr_b16 v[20:21], v253 offset:0
    ds_read_b64_tr_b16 v[22:23], v253 offset:1024
    ds_read_b64_tr_b16 v[24:25], v252 offset:2048
    ds_read_b64_tr_b16 v[26:27], v254 offset:1024
    ds_read_b64_tr_b16 v[28:29], v253 offset:2048
    ds_read_b64_tr_b16 v[30:31], v255 offset:1024
    ds_read_b64_tr_b16 v[32:33], v254 offset:2048
    ds_read_b64_tr_b16 v[34:35], v254 offset:3072
    ds_read_b64_tr_b16 v[36:37], v255 offset:2048
    ds_read_b64_tr_b16 v[38:39], v255 offset:3072
    ds_read_b64_tr_b16 v[40:41], v252 offset:12288
    ds_read_b64_tr_b16 v[42:43], v252 offset:13312
    ds_read_b64_tr_b16 v[44:45], v253 offset:12288
    ds_read_b64_tr_b16 v[46:47], v253 offset:13312
    ds_read_b64_tr_b16 v[48:49], v252 offset:14336
    ds_read_b64_tr_b16 v[50:51], v254 offset:16384
    ds_read_b64_tr_b16 v[52:53], v253 offset:14336
    ds_read_b64_tr_b16 v[54:55], v255 offset:16384
    ds_read_b64_tr_b16 v[56:57], v254 offset:17408
    ds_read_b64_tr_b16 v[58:59], v254 offset:18432
    ds_read_b64_tr_b16 v[60:61], v255 offset:17408
    ds_read_b64_tr_b16 v[62:63], v255 offset:18432
    ds_read_b64_tr_b16 v[64:65], v254 offset:19456
    ds_read_b64_tr_b16 v[66:67], v252 offset:24576
    ds_read_b64_tr_b16 v[68:69], v255 offset:19456
    ds_read_b64_tr_b16 v[70:71], v253 offset:24576
    ds_read_b64_tr_b16 v[72:73], v252 offset:25600
    ds_read_b64_tr_b16 v[74:75], v252 offset:26624
    ds_read_b64_tr_b16 v[76:77], v253 offset:25600
    ds_read_b64_tr_b16 v[78:79], v253 offset:26624
    s_waitcnt lgkmcnt(0)
    s_add_u32 s23, s79, 8
    s_cmp_ge_u32 s23, s48
    s_cselect_b32 s63, s48, 0
    s_sub_u32 s23, s23, s63
    s_lshl_b32 s23, s23, 14
    s_add_u32 s23, s23, s59
    s_add_u32 s63, s23, 0
    s_add_u32 m0, s57, 0
    s_nop 0
    buffer_load_dwordx4 v15, s[32:35], s63 offen lds
    s_add_u32 s63, s23, 8192
    s_add_u32 m0, s57, 1024
    s_nop 0
    buffer_load_dwordx4 v15, s[32:35], s63 offen lds
    s_add_u32 s23, s79, 9
    s_cmp_ge_u32 s23, s48
    s_cselect_b32 s63, s48, 0
    s_sub_u32 s23, s23, s63
    s_lshl_b32 s23, s23, 14
    s_add_u32 s23, s23, s59
    s_add_u32 s63, s23, 0
    s_add_u32 m0, s57, 2048
    s_nop 0
    buffer_load_dwordx4 v15, s[32:35], s63 offen lds
    s_add_u32 s63, s23, 8192
    s_add_u32 m0, s61, 1024
    s_nop 0
    buffer_load_dwordx4 v15, s[32:35], s63 offen lds
    s_add_u32 s23, s79, 10
    s_cmp_ge_u32 s23, s48
    s_cselect_b32 s63, s48, 0
    s_sub_u32 s23, s23, s63
    s_lshl_b32 s23, s23, 14
    s_add_u32 s23, s23, s59
    s_add_u32 s63, s23, 0
    s_add_u32 m0, s61, 2048
    s_nop 0
    buffer_load_dwordx4 v15, s[32:35], s63 offen lds
    s_add_u32 s63, s23, 8192
    s_add_u32 m0, s61, 3072
    s_nop 0
    buffer_load_dwordx4 v15, s[32:35], s63 offen lds
    s_add_u32 s23, s79, 13
    s_cmp_ge_u32 s23, s48
    s_cselect_b32 s63, s48, 0
    s_sub_u32 s23, s23, s63
    s_lshl_b32 s23, s23, 14
    s_add_u32 s23, s23, s59
    s_add_u32 s63, s23, 0
    s_add_u32 m0, s57, 12288
    s_nop 0
    buffer_load_dwordx4 v15, s[32:35], s63 offen lds
    s_add_u32 s63, s23, 8192
    s_add_u32 m0, s57, 13312
    s_nop 0
    buffer_load_dwordx4 v15, s[32:35], s63 offen lds
    s_add_u32 s23, s79, 14
    s_cmp_ge_u32 s23, s48
    s_cselect_b32 s63, s48, 0
    s_sub_u32 s23, s23, s63
    s_lshl_b32 s23, s23, 14
    s_add_u32 s23, s23, s59
    s_add_u32 s63, s23, 0
    s_add_u32 m0, s57, 14336
    s_nop 0
    buffer_load_dwordx4 v15, s[32:35], s63 offen lds
    s_add_u32 s63, s23, 8192
    s_add_u32 m0, s61, 16384
    s_nop 0
    buffer_load_dwordx4 v15, s[32:35], s63 offen lds
    s_waitcnt vmcnt(4)
    ds_read_b64_tr_b16 v[80:81], v252 offset:0
    ds_read_b64_tr_b16 v[82:83], v252 offset:1024
    ds_read_b64_tr_b16 v[84:85], v253 offset:0
    ds_read_b64_tr_b16 v[86:87], v253 offset:1024
    ds_read_b64_tr_b16 v[88:89], v252 offset:2048
    ds_read_b64_tr_b16 v[90:91], v254 offset:1024
    ds_read_b64_tr_b16 v[92:93], v253 offset:2048
    ds_read_b64_tr_b16 v[94:95], v255 offset:1024
    ds_read_b64_tr_b16 v[96:97], v254 offset:2048
    ds_read_b64_tr_b16 v[98:99], v254 offset:3072
    ds_read_b64_tr_b16 v[100:101], v255 offset:2048
    ds_read_b64_tr_b16 v[102:103], v255 offset:3072
L_M_join:
    s_add_u32 s23, s79, 11
    s_cmp_ge_u32 s23, s48
    s_cselect_b32 s63, s48, 0
    s_sub_u32 s23, s23, s63
    s_lshl_b32 s23, s23, 14
    s_add_u32 s23, s23, s59
    s_add_u32 s63, s23, 0
    s_add_u32 m0, s57, 36864
    s_nop 0
    buffer_load_dwordx4 v15, s[32:35], s63 offen lds
    s_add_u32 s63, s23, 8192
    s_add_u32 m0, s57, 37888
    s_nop 0
    buffer_load_dwordx4 v15, s[32:35], s63 offen lds
    s_add_u32 s23, s79, 12
    s_cmp_ge_u32 s23, s48
    s_cselect_b32 s63, s48, 0
    s_sub_u32 s23, s23, s63
    s_lshl_b32 s23, s23, 14
    s_add_u32 s23, s23, s59
    s_add_u32 s63, s23, 0
    s_add_u32 m0, s57, 38912
    s_nop 0
    buffer_load_dwordx4 v15, s[32:35], s63 offen lds
    s_add_u32 s63, s23, 8192
    s_add_u32 m0, s61, 0
    s_nop 0
    buffer_load_dwordx4 v15, s[32:35], s63 offen lds
    s_waitcnt lgkmcnt(0)
    s_add_u32 s23, s79, 15
    s_cmp_ge_u32 s23, s48
    s_cselect_b32 s63, s48, 0
    s_sub_u32 s23, s23, s63
    s_lshl_b32 s23, s23, 14
    s_add_u32 s23, s23, s59
    s_add_u32 s63, s23, 0
    s_add_u32 m0, s61, 17408
    s_nop 0
    buffer_load_dwordx4 v15, s[32:35], s63 offen lds
    s_add_u32 s63, s23, 8192
    s_add_u32 m0, s61, 18432
    s_nop 0
    buffer_load_dwordx4 v15, s[32:35], s63 offen lds
    s_add_u32 s23, s79, 16
    s_cmp_ge_u32 s23, s48
    s_cselect_b32 s63, s48, 0
    s_sub_u32 s23, s23, s63
    s_lshl_b32 s23, s23, 14
    s_add_u32 s23, s23, s59
    s_add_u32 s63, s23, 0
    s_add_u32 m0, s61, 19456
    s_nop 0
    buffer_load_dwordx4 v15, s[32:35], s63 offen lds
    s_add_u32 s63, s23, 8192
    s_add_u32 m0, s57, 24576
    s_nop 0
    buffer_load_dwordx4 v15, s[32:35], s63 offen lds
    s_add_u32 s23, s79, 17
    s_cmp_ge_u32 s23, s48
    s_cselect_b32 s63, s48, 0
    s_sub_u32 s23, s23, s63
    s_lshl_b32 s23, s23, 14
    s_add_u32 s23, s23, s59
    s_add_u32 s63, s23, 0
    s_add_u32 m0, s57, 25600
    s_nop 0
    buffer_load_dwordx4 v15, s[32:35], s63 offen lds
    s_add_u32 s63, s23, 8192
    s_add_u32 m0, s57, 26624
    s_nop 0
    buffer_load_dwordx4 v15, s[32:35], s63 offen lds
    s_add_u32 s23, s79, 18
    s_cmp_ge_u32 s23, s48
    s_cselect_b32 s63, s48, 0
    s_sub_u32 s23, s23, s63
    s_lshl_b32 s23, s23, 14
    s_add_u32 s23, s23, s59
    s_add_u32 s63, s23, 0
    s_add_u32 m0, s57, 0
    s_nop 0
    buffer_load_dwordx4 v15, s[32:35], s63 offen lds
    s_add_u32 s63, s23, 8192
    s_add_u32 m0, s57, 1024
    s_nop 0
    buffer_load_dwordx4 v15, s[32:35], s63 offen lds
    s_add_u32 s23, s79, 19
    s_cmp_ge_u32 s23, s48
    s_cselect_b32 s63, s48, 0
    s_sub_u32 s23, s23, s63
    s_lshl_b32 s23, s23, 14
    s_add_u32 s23, s23, s59
    s_add_u32 s63, s23, 0
    s_add_u32 m0, s57, 2048
    s_nop 0
    buffer_load_dwordx4 v15, s[32:35], s63 offen lds
    s_add_u32 s63, s23, 8192
    s_add_u32 m0, s61, 1024
    s_nop 0
    buffer_load_dwordx4 v15, s[32:35], s63 offen lds
    s_add_u32 s23, s79, 20
    s_cmp_ge_u32 s23, s48
    s_cselect_b32 s63, s48, 0
    s_sub_u32 s23, s23, s63
    s_lshl_b32 s23, s23, 14
    s_add_u32 s23, s23, s59
    s_add_u32 s63, s23, 0
    s_add_u32 m0, s61, 2048
    s_nop 0
    buffer_load_dwordx4 v15, s[32:35], s63 offen lds
    s_add_u32 s63, s23, 8192
    s_add_u32 m0, s61, 3072
    s_nop 0
    buffer_load_dwordx4 v15, s[32:35], s63 offen lds
    v_min_u32 v13, 14, v1
    v_lshlrev_b32_e64 v13, 7, v13
    s_lshr_b32 s65, s51, 1
    s_lshl_b32 s65, s65, 11
    s_add_u32 s65, s65, 0xc10000
    s_lshl_b32 s54, s51, 16
    s_lshl_b32 s55, s22, 14
    s_add_u32 s54, s54, s55
    s_add_u32 s54, s54, s60
    s_add_u32 s55, s54, 8192
    s_mul_i32 s56, s51, 172
    s_add_u32 s56, s56, s58
    s_lshl_b32 s56, s56, 10
    s_add_u32 s56, s56, 0x400000
    s_add_u32 s62, s56, 88064
    v_lshl_add_u32 v6, v5, 1, s60
    s_waitcnt vmcnt(14)
    ds_read_b64_tr_b16 v[104:105], v252 offset:36864
    ds_read_b64_tr_b16 v[106:107], v252 offset:37888
    ds_read_b64_tr_b16 v[108:109], v253 offset:36864
    ds_read_b64_tr_b16 v[110:111], v253 offset:37888
    s_waitcnt lgkmcnt(0)
    s_add_u32 s23, s79, 21
    s_cmp_ge_u32 s23, s48
    s_cselect_b32 s63, s48, 0
    s_sub_u32 s23, s23, s63
    s_lshl_b32 s23, s23, 14
    s_add_u32 s23, s23, s59
    s_add_u32 s63, s23, 0
    s_add_u32 m0, s57, 36864
    s_nop 0
    buffer_load_dwordx4 v15, s[32:35], s63 offen lds
    s_add_u32 s63, s23, 8192
    s_add_u32 m0, s57, 37888
    s_nop 0
    buffer_load_dwordx4 v15, s[32:35], s63 offen lds
    s_cmp_lg_u32 s22, 0
    s_cbranch_scc1 L_M_p2w
    s_mov_b64 exec, 0x7fff
    buffer_load_dword v11, v13, s[24:27], s65 offen sc1
    s_mov_b32 s70, 262144
    s_waitcnt vmcnt(0)
L_M_p2:
    v_cmp_ne_u32_e64 vcc, v11, v14
    s_cbranch_vccz L_M_p2_ok
    s_sub_u32 s70, s70, 1
    s_cbranch_scc1 L_M_p2_ok
    s_sleep 2
    buffer_load_dword v11, v13, s[24:27], s65 offen sc1
    s_waitcnt vmcnt(0)
    s_branch L_M_p2
L_M_p2_ok:
    s_mov_b64 exec, -1
L_M_p2w:
    s_barrier
    s_setprio 1
    s_add_u32 s23, s79, 0
    s_cmp_ge_u32 s23, s48
    s_cselect_b32 s63, s48, 0
    s_sub_u32 s23, s23, s63
    s_lshl_b32 s23, s23, 10
    s_add_u32 s63, s23, s56
    s_add_u32 s23, s23, s62
    buffer_load_dwordx4 v[192:195], v2, s[24:27], s63 offen sc1
    buffer_load_dwordx4 v[196:199], v2, s[24:27], s23 offen sc1
    s_add_u32 s23, s79, 1
    s_cmp_ge_u32 s23, s48
    s_cselect_b32 s63, s48, 0
    s_sub_u32 s23, s23, s63
    s_lshl_b32 s23, s23, 10
    s_add_u32 s63, s23, s56
    s_add_u32 s23, s23, s62
    buffer_load_dwordx4 v[200:203], v2, s[24:27], s63 offen sc1
    buffer_load_dwordx4 v[204:207], v2, s[24:27], s23 offen sc1
    s_add_u32 s23, s79, 2
    s_cmp_ge_u32 s23, s48
    s_cselect_b32 s63, s48, 0
    s_sub_u32 s23, s23, s63
    s_lshl_b32 s23, s23, 10
    s_add_u32 s63, s23, s56
    s_add_u32 s23, s23, s62
    buffer_load_dwordx4 v[208:211], v2, s[24:27], s63 offen sc1
    buffer_load_dwordx4 v[212:215], v2, s[24:27], s23 offen sc1
    s_add_u32 s23, s79, 3
    s_cmp_ge_u32 s23, s48
    s_cselect_b32 s63, s48, 0
    s_sub_u32 s23, s23, s63
    s_lshl_b32 s23, s23, 10
    s_add_u32 s63, s23, s56
    s_add_u32 s23, s23, s62
    buffer_load_dwordx4 v[216:219], v2, s[24:27], s63 offen sc1
    buffer_load_dwordx4 v[220:223], v2, s[24:27], s23 offen sc1
    s_add_u32 s23, s79, 4
    s_cmp_ge_u32 s23, s48
    s_cselect_b32 s63, s48, 0
    s_sub_u32 s23, s23, s63
    s_lshl_b32 s23, s23, 10
    s_add_u32 s63, s23, s56
    s_add_u32 s23, s23, s62
    buffer_load_dwordx4 v[224:227], v2, s[24:27], s63 offen sc1
    buffer_load_dwordx4 v[228:231], v2, s[24:27], s23 offen sc1
    s_add_u32 s23, s79, 5
    s_cmp_ge_u32 s23, s48
    s_cselect_b32 s63, s48, 0
    s_sub_u32 s23, s23, s63
    s_lshl_b32 s23, s23, 10
    s_add_u32 s63, s23, s56
    s_add_u32 s23, s23, s62
    buffer_load_dwordx4 v[232:235], v2, s[24:27], s63 offen sc1
    buffer_load_dwordx4 v[236:239], v2, s[24:27], s23 offen sc1
    s_add_u32 s23, s79, 6
    s_cmp_ge_u32 s23, s48
    s_cselect_b32 s63, s48, 0
    s_sub_u32 s23, s23, s63
    s_lshl_b32 s23, s23, 10
    s_add_u32 s63, s23, s56
    s_add_u32 s23, s23, s62
    buffer_load_dwordx4 v[112:115], v2, s[24:27], s63 offen sc1
    buffer_load_dwordx4 v[116:119], v2, s[24:27], s23 offen sc1
    s_add_u32 s23, s79, 7
    s_cmp_ge_u32 s23, s48
    s_cselect_b32 s63, s48, 0
    s_sub_u32 s23, s23, s63
    s_lshl_b32 s23, s23, 10
    s_add_u32 s63, s23, s56
    s_add_u32 s23, s23, s62
    buffer_load_dwordx4 v[120:123], v2, s[24:27], s63 offen sc1
    buffer_load_dwordx4 v[124:127], v2, s[24:27], s23 offen sc1
    v_and_b32 v13, 7, v1
    v_lshlrev_b32 v8, 4, v13
    v_lshlrev_b32_e64 v13, 7, v13
    s_lshl_b32 s65, s52, 12
    s_lshl_b32 s71, s22, 10
    s_add_u32 s65, s65, s71
    s_add_u32 s65, s65, 0xc20000
    v_lshrrev_b32_e64 v7, 3, v1
    v_lshl_add_u32 v7, v7, 12, v8
    s_lshl_b32 s67, s52, 18
    s_lshl_b32 s68, s22, 16
    s_add_u32 s67, s67, s68
    s_lshl_b32 s68, s51, 7
    s_add_u32 s67, s67, s68
    s_add_u32 s67, s67, 0xa00000
    s_add_u32 s68, s67, 32768
    s_mov_b32 s75, 0
    s_waitcnt vmcnt(14)
    v_mfma_f32_32x32x16_bf16 v[128:143], v[192:195], v[16:19], 0
    v_mfma_f32_32x32x16_bf16 v[144:159], v[192:195], v[20:23], 0
    v_mfma_f32_32x32x16_bf16 v[160:175], v[196:199], v[16:19], 0
    v_mfma_f32_32x32x16_bf16 v[176:191], v[196:199], v[20:23], 0
    s_add_u32 s23, s79, 8
    s_cmp_ge_u32 s23, s48
    s_cselect_b32 s63, s48, 0
    s_sub_u32 s23, s23, s63
    s_lshl_b32 s23, s23, 10
    s_add_u32 s63, s23, s56
    s_add_u32 s23, s23, s62
    buffer_load_dwordx4 v[192:195], v2, s[24:27], s63 offen sc1
    buffer_load_dwordx4 v[196:199], v2, s[24:27], s23 offen sc1
    ds_read_b64_tr_b16 v[16:17], v252 offset:38912
    ds_read_b64_tr_b16 v[18:19], v254 offset:0
    ds_read_b64_tr_b16 v[20:21], v253 offset:38912
    ds_read_b64_tr_b16 v[22:23], v255 offset:0
    s_waitcnt vmcnt(14)
    v_mfma_f32_32x32x16_bf16 v[128:143], v[200:203], v[24:27], v[128:143]
    v_mfma_f32_32x32x16_bf16 v[144:159], v[200:203], v[28:31], v[144:159]
    v_mfma_f32_32x32x16_bf16 v[160:175], v[204:207], v[24:27], v[160:175]
    v_mfma_f32_32x32x16_bf16 v[176:191], v[204:207], v[28:31], v[176:191]
    s_add_u32 s23, s79, 9
    s_cmp_ge_u32 s23, s48
    s_cselect_b32 s63, s48, 0
    s_sub_u32 s23, s23, s63
    s_lshl_b32 s23, s23, 10
    s_add_u32 s63, s23, s56
    s_add_u32 s23, s23, s62
    buffer_load_dwordx4 v[200:203], v2, s[24:27], s63 offen sc1
    buffer_load_dwordx4 v[204:207], v2, s[24:27], s23 offen sc1
    ds_read_b64_tr_b16 v[24:25], v252 offset:12288
    ds_read_b64_tr_b16 v[26:27], v252 offset:13312
    ds_read_b64_tr_b16 v[28:29], v253 offset:12288
    ds_read_b64_tr_b16 v[30:31], v253 offset:13312
    s_waitcnt vmcnt(14)
    v_mfma_f32_32x32x16_bf16 v[128:143], v[208:211], v[32:35], v[128:143]
    v_mfma_f32_32x32x16_bf16 v[144:159], v[208:211], v[36:39], v[144:159]
    v_mfma_f32_32x32x16_bf16 v[160:175], v[212:215], v[32:35], v[160:175]
    v_mfma_f32_32x32x16_bf16 v[176:191], v[212:215], v[36:39], v[176:191]
    s_add_u32 s23, s79, 10
    s_cmp_ge_u32 s23, s48
    s_cselect_b32 s63, s48, 0
    s_sub_u32 s23, s23, s63
    s_lshl_b32 s23, s23, 10
    s_add_u32 s63, s23, s56
    s_add_u32 s23, s23, s62
    buffer_load_dwordx4 v[208:211], v2, s[24:27], s63 offen sc1
    buffer_load_dwordx4 v[212:215], v2, s[24:27], s23 offen sc1
    ds_read_b64_tr_b16 v[32:33], v252 offset:14336
    ds_read_b64_tr_b16 v[34:35], v254 offset:16384
    ds_read_b64_tr_b16 v[36:37], v253 offset:14336
    ds_read_b64_tr_b16 v[38:39], v255 offset:16384
    s_waitcnt vmcnt(14)
    v_mfma_f32_32x32x16_bf16 v[128:143], v[216:219], v[40:43], v[128:143]
    v_mfma_f32_32x32x16_bf16 v[144:159], v[216:219], v[44:47], v[144:159]
    v_mfma_f32_32x32x16_bf16 v[160:175], v[220:223], v[40:43], v[160:175]
    v_mfma_f32_32x32x16_bf16 v[176:191], v[220:223], v[44:47], v[176:191]
    s_add_u32 s23, s79, 11
    s_cmp_ge_u32 s23, s48
    s_cselect_b32 s63, s48, 0
    s_sub_u32 s23, s23, s63
    s_lshl_b32 s23, s23, 10
    s_add_u32 s63, s23, s56
    s_add_u32 s23, s23, s62
    buffer_load_dwordx4 v[216:219], v2, s[24:27], s63 offen sc1
    buffer_load_dwordx4 v[220:223], v2, s[24:27], s23 offen sc1
    ds_read_b64_tr_b16 v[40:41], v254 offset:17408
    ds_read_b64_tr_b16 v[42:43], v254 offset:18432
    ds_read_b64_tr_b16 v[44:45], v255 offset:17408
    ds_read_b64_tr_b16 v[46:47], v255 offset:18432
    s_waitcnt vmcnt(14)
    v_mfma_f32_32x32x16_bf16 v[128:143], v[224:227], v[48:51], v[128:143]
    v_mfma_f32_32x32x16_bf16 v[144:159], v[224:227], v[52:55], v[144:159]
    v_mfma_f32_32x32x16_bf16 v[160:175], v[228:231], v[48:51], v[160:175]
    v_mfma_f32_32x32x16_bf16 v[176:191], v[228:231], v[52:55], v[176:191]
    s_add_u32 s23, s79, 12
    s_cmp_ge_u32 s23, s48
    s_cselect_b32 s63, s48, 0
    s_sub_u32 s23, s23, s63
    s_lshl_b32 s23, s23, 10
    s_add_u32 s63, s23, s56
    s_add_u32 s23, s23, s62
    buffer_load_dwordx4 v[224:227], v2, s[24:27], s63 offen sc1
    buffer_load_dwordx4 v[228:231], v2, s[24:27], s23 offen sc1
    ds_read_b64_tr_b16 v[48:49], v254 offset:19456
    ds_read_b64_tr_b16 v[50:51], v252 offset:24576
    ds_read_b64_tr_b16 v[52:53], v255 offset:19456
    ds_read_b64_tr_b16 v[54:55], v253 offset:24576
    s_waitcnt vmcnt(14)
    v_mfma_f32_32x32x16_bf16 v[128:143], v[232:235], v[56:59], v[128:143]
    v_mfma_f32_32x32x16_bf16 v[144:159], v[232:235], v[60:63], v[144:159]
    v_mfma_f32_32x32x16_bf16 v[160:175], v[236:239], v[56:59], v[160:175]
    v_mfma_f32_32x32x16_bf16 v[176:191], v[236:239], v[60:63], v[176:191]
    s_add_u32 s23, s79, 13
    s_cmp_ge_u32 s23, s48
    s_cselect_b32 s63, s48, 0
    s_sub_u32 s23, s23, s63
    s_lshl_b32 s23, s23, 10
    s_add_u32 s63, s23, s56
    s_add_u32 s23, s23, s62
    buffer_load_dwordx4 v[232:235], v2, s[24:27], s63 offen sc1
    buffer_load_dwordx4 v[236:239], v2, s[24:27], s23 offen sc1
    ds_read_b64_tr_b16 v[56:57], v252 offset:25600
    ds_read_b64_tr_b16 v[58:59], v252 offset:26624
    ds_read_b64_tr_b16 v[60:61], v253 offset:25600
    ds_read_b64_tr_b16 v[62:63], v253 offset:26624
    s_waitcnt vmcnt(14)
    v_mfma_f32_32x32x16_bf16 v[128:143], v[112:115], v[64:67], v[128:143]
    v_mfma_f32_32x32x16_bf16 v[144:159], v[112:115], v[68:71], v[144:159]
    v_mfma_f32_32x32x16_bf16 v[160:175], v[116:119], v[64:67], v[160:175]
    v_mfma_f32_32x32x16_bf16 v[176:191], v[116:119], v[68:71], v[176:191]
    s_add_u32 s23, s79, 14
    s_cmp_ge_u32 s23, s48
    s_cselect_b32 s63, s48, 0
    s_sub_u32 s23, s23, s63
    s_lshl_b32 s23, s23, 10
    s_add_u32 s63, s23, s56
    s_add_u32 s23, s23, s62
    buffer_load_dwordx4 v[112:115], v2, s[24:27], s63 offen sc1
    buffer_load_dwordx4 v[116:119], v2, s[24:27], s23 offen sc1
    ds_read_b64_tr_b16 v[64:65], v252 offset:0
    ds_read_b64_tr_b16 v[66:67], v252 offset:1024
    ds_read_b64_tr_b16 v[68:69], v253 offset:0
    ds_read_b64_tr_b16 v[70:71], v253 offset:1024
    s_waitcnt vmcnt(14)
    v_mfma_f32_32x32x16_bf16 v[128:143], v[120:123], v[72:75], v[128:143]
    v_mfma_f32_32x32x16_bf16 v[144:159], v[120:123], v[76:79], v[144:159]
    v_mfma_f32_32x32x16_bf16 v[160:175], v[124:127], v[72:75], v[160:175]
    v_mfma_f32_32x32x16_bf16 v[176:191], v[124:127], v[76:79], v[176:191]
    s_add_u32 s23, s79, 15
    s_cmp_ge_u32 s23, s48
    s_cselect_b32 s63, s48, 0
    s_sub_u32 s23, s23, s63
    s_lshl_b32 s23, s23, 10
    s_add_u32 s63, s23, s56
    s_add_u32 s23, s23, s62
    buffer_load_dwordx4 v[120:123], v2, s[24:27], s63 offen sc1
    buffer_load_dwordx4 v[124:127], v2, s[24:27], s23 offen sc1
    ds_read_b64_tr_b16 v[72:73], v252 offset:2048
    ds_read_b64_tr_b16 v[74:75], v254 offset:1024
    ds_read_b64_tr_b16 v[76:77], v253 offset:2048
    ds_read_b64_tr_b16 v[78:79], v255 offset:1024
    s_waitcnt vmcnt(14)
    v_mfma_f32_32x32x16_bf16 v[128:143], v[192:195], v[80:83], v[128:143]
    v_mfma_f32_32x32x16_bf16 v[144:159], v[192:195], v[84:87], v[144:159]
    v_mfma_f32_32x32x16_bf16 v[160:175], v[196:199], v[80:83], v[160:175]
    v_mfma_f32_32x32x16_bf16 v[176:191], v[196:199], v[84:87], v[176:191]
    s_add_u32 s23, s79, 16
    s_cmp_ge_u32 s23, s48
    s_cselect_b32 s63, s48, 0
    s_sub_u32 s23, s23, s63
    s_lshl_b32 s23, s23, 10
    s_add_u32 s63, s23, s56
    s_add_u32 s23, s23, s62
    buffer_load_dwordx4 v[192:195], v2, s[24:27], s63 offen sc1
    buffer_load_dwordx4 v[196:199], v2, s[24:27], s23 offen sc1
    ds_read_b64_tr_b16 v[80:81], v254 offset:2048
    ds_read_b64_tr_b16 v[82:83], v254 offset:3072
    ds_read_b64_tr_b16 v[84:85], v255 offset:2048
    ds_read_b64_tr_b16 v[86:87], v255 offset:3072
    s_waitcnt vmcnt(14)
    v_mfma_f32_32x32x16_bf16 v[128:143], v[200:203], v[88:91], v[128:143]
    v_mfma_f32_32x32x16_bf16 v[144:159], v[200:203], v[92:95], v[144:159]
    v_mfma_f32_32x32x16_bf16 v[160:175], v[204:207], v[88:91], v[160:175]
    v_mfma_f32_32x32x16_bf16 v[176:191], v[204:207], v[92:95], v[176:191]
    s_add_u32 s23, s79, 17
    s_cmp_ge_u32 s23, s48
    s_cselect_b32 s63, s48, 0
    s_sub_u32 s23, s23, s63
    s_lshl_b32 s23, s23, 10
    s_add_u32 s63, s23, s56
    s_add_u32 s23, s23, s62
    buffer_load_dwordx4 v[200:203], v2, s[24:27], s63 offen sc1
    buffer_load_dwordx4 v[204:207], v2, s[24:27], s23 offen sc1
    ds_read_b64_tr_b16 v[88:89], v252 offset:36864
    ds_read_b64_tr_b16 v[90:91], v252 offset:37888
    ds_read_b64_tr_b16 v[92:93], v253 offset:36864
    ds_read_b64_tr_b16 v[94:95], v253 offset:37888
    s_waitcnt vmcnt(14)
    v_mfma_f32_32x32x16_bf16 v[128:143], v[208:211], v[96:99], v[128:143]
    v_mfma_f32_32x32x16_bf16 v[144:159], v[208:211], v[100:103], v[144:159]
    v_mfma_f32_32x32x16_bf16 v[160:175], v[212:215], v[96:99], v[160:175]
    v_mfma_f32_32x32x16_bf16 v[176:191], v[212:215], v[100:103], v[176:191]
    s_add_u32 s23, s79, 18
    s_cmp_ge_u32 s23, s48
    s_cselect_b32 s63, s48, 0
    s_sub_u32 s23, s23, s63
    s_lshl_b32 s23, s23, 10
    s_add_u32 s63, s23, s56
    s_add_u32 s23, s23, s62
    buffer_load_dwordx4 v[208:211], v2, s[24:27], s63 offen sc1
    buffer_load_dwordx4 v[212:215], v2, s[24:27], s23 offen sc1
    s_waitcnt vmcnt(14)
    v_mfma_f32_32x32x16_bf16 v[128:143], v[216:219], v[104:107], v[128:143]
    v_mfma_f32_32x32x16_bf16 v[144:159], v[216:219], v[108:111], v[144:159]
    v_mfma_f32_32x32x16_bf16 v[160:175], v[220:223], v[104:107], v[160:175]
    v_mfma_f32_32x32x16_bf16 v[176:191], v[220:223], v[108:111], v[176:191]
    s_add_u32 s23, s79, 19
    s_cmp_ge_u32 s23, s48
    s_cselect_b32 s63, s48, 0
    s_sub_u32 s23, s23, s63
    s_lshl_b32 s23, s23, 10
    s_add_u32 s63, s23, s56
    s_add_u32 s23, s23, s62
    buffer_load_dwordx4 v[216:219], v2, s[24:27], s63 offen sc1
    buffer_load_dwordx4 v[220:223], v2, s[24:27], s23 offen sc1
    s_waitcnt vmcnt(14)
    s_waitcnt lgkmcnt(15)
    v_mfma_f32_32x32x16_bf16 v[128:143], v[224:227], v[16:19], v[128:143]
    v_mfma_f32_32x32x16_bf16 v[144:159], v[224:227], v[20:23], v[144:159]
    v_mfma_f32_32x32x16_bf16 v[160:175], v[228:231], v[16:19], v[160:175]
    v_mfma_f32_32x32x16_bf16 v[176:191], v[228:231], v[20:23], v[176:191]
    s_add_u32 s23, s79, 20
    s_cmp_ge_u32 s23, s48
    s_cselect_b32 s63, s48, 0
    s_sub_u32 s23, s23, s63
    s_lshl_b32 s23, s23, 10
    s_add_u32 s63, s23, s56
    s_add_u32 s23, s23, s62
    buffer_load_dwordx4 v[224:227], v2, s[24:27], s63 offen sc1
    buffer_load_dwordx4 v[228:231], v2, s[24:27], s23 offen sc1
    s_waitcnt vmcnt(14)
    s_waitcnt lgkmcnt(15)
    v_mfma_f32_32x32x16_bf16 v[128:143], v[232:235], v[24:27], v[128:143]
    v_mfma_f32_32x32x16_bf16 v[144:159], v[232:235], v[28:31], v[144:159]
    v_mfma_f32_32x32x16_bf16 v[160:175], v[236:239], v[24:27], v[160:175]
    v_mfma_f32_32x32x16_bf16 v[176:191], v[236:239], v[28:31], v[176:191]
    s_add_u32 s23, s79, 21
    s_cmp_ge_u32 s23, s48
    s_cselect_b32 s63, s48, 0
    s_sub_u32 s23, s23, s63
    s_lshl_b32 s23, s23, 10
    s_add_u32 s63, s23, s56
    s_add_u32 s23, s23, s62
    buffer_load_dwordx4 v[232:235], v2, s[24:27], s63 offen sc1
    buffer_load_dwordx4 v[236:239], v2, s[24:27], s23 offen sc1
    buffer_load_dword v11, v13, s[24:27], s65 offen sc1
    s_waitcnt vmcnt(15)
    s_waitcnt lgkmcnt(15)
    v_mfma_f32_32x32x16_bf16 v[128:143], v[112:115], v[32:35], v[128:143]
    v_mfma_f32_32x32x16_bf16 v[144:159], v[112:115], v[36:39], v[144:159]
    v_mfma_f32_32x32x16_bf16 v[160:175], v[116:119], v[32:35], v[160:175]
    v_mfma_f32_32x32x16_bf16 v[176:191], v[116:119], v[36:39], v[176:191]
    buffer_load_dword v240, v9, s[40:43], s54 offen offset:0
    buffer_load_dword v241, v9, s[40:43], s54 offen offset:2048
    s_lshl_b32 s74, s51, 10
    s_lshl_b32 s71, s22, 8
    s_add_u32 s74, s74, s71
    s_add_u32 s74, s74, 0xc60004
    v_lshlrev_b32 v8, 6, v4
    buffer_load_dword v96, v8, s[24:27], s74 offen offset:0 sc1
    buffer_load_dword v97, v8, s[24:27], s74 offen offset:16 sc1
    s_waitcnt vmcnt(17)
    s_waitcnt lgkmcnt(15)
    v_mfma_f32_32x32x16_bf16 v[128:143], v[120:123], v[40:43], v[128:143]
    v_mfma_f32_32x32x16_bf16 v[144:159], v[120:123], v[44:47], v[144:159]
    v_mfma_f32_32x32x16_bf16 v[160:175], v[124:127], v[40:43], v[160:175]
    v_mfma_f32_32x32x16_bf16 v[176:191], v[124:127], v[44:47], v[176:191]
    buffer_load_dword v242, v9, s[40:43], s55 offen offset:0
    buffer_load_dword v243, v9, s[40:43], s55 offen offset:2048
    buffer_load_dword v98, v8, s[24:27], s74 offen offset:32 sc1
    buffer_load_dword v99, v8, s[24:27], s74 offen offset:48 sc1
    s_waitcnt vmcnt(19)
    s_waitcnt lgkmcnt(15)
    v_mfma_f32_32x32x16_bf16 v[128:143], v[192:195], v[48:51], v[128:143]
    v_mfma_f32_32x32x16_bf16 v[144:159], v[192:195], v[52:55], v[144:159]
    v_mfma_f32_32x32x16_bf16 v[160:175], v[196:199], v[48:51], v[160:175]
    v_mfma_f32_32x32x16_bf16 v[176:191], v[196:199], v[52:55], v[176:191]
    buffer_load_dword v244, v9, s[40:43], s54 offen offset:64
    buffer_load_dword v245, v9, s[40:43], s54 offen offset:2112
    buffer_load_dword v100, v8, s[24:27], s74 offen offset:128 sc1
    buffer_load_dword v101, v8, s[24:27], s74 offen offset:144 sc1
    s_waitcnt vmcnt(21)
    s_waitcnt lgkmcnt(15)
    v_mfma_f32_32x32x16_bf16 v[128:143], v[200:203], v[56:59], v[128:143]
    v_mfma_f32_32x32x16_bf16 v[144:159], v[200:203], v[60:63], v[144:159]
    v_mfma_f32_32x32x16_bf16 v[160:175], v[204:207], v[56:59], v[160:175]
    v_mfma_f32_32x32x16_bf16 v[176:191], v[204:207], v[60:63], v[176:191]
    buffer_load_dword v246, v9, s[40:43], s55 offen offset:64
    buffer_load_dword v247, v9, s[40:43], s55 offen offset:2112
    buffer_load_dword v102, v8, s[24:27], s74 offen offset:160 sc1
    buffer_load_dword v103, v8, s[24:27], s74 offen offset:176 sc1
    global_load_ushort v12, v6, s[14:15]
    global_load_ushort v3, v6, s[14:15] offset:64
    s_waitcnt vmcnt(25)
    s_waitcnt lgkmcnt(12)
    v_mfma_f32_32x32x16_bf16 v[128:143], v[208:211], v[64:67], v[128:143]
    v_mfma_f32_32x32x16_bf16 v[144:159], v[208:211], v[68:71], v[144:159]
    v_mfma_f32_32x32x16_bf16 v[160:175], v[212:215], v[64:67], v[160:175]
    v_mfma_f32_32x32x16_bf16 v[176:191], v[212:215], v[68:71], v[176:191]
    s_waitcnt vmcnt(18)
    v_cmp_ne_u32_e64 vcc, v11, v14
    s_cbranch_vccnz L_M_s_no
    buffer_load_dwordx4 v[248:251], v7, s[24:27], s67 offen sc1
    buffer_load_dwordx4 v[104:107], v7, s[24:27], s68 offen sc1
    s_mov_b32 s75, 1
L_M_s_no:
    s_waitcnt vmcnt(23)
    s_waitcnt lgkmcnt(8)
    v_mfma_f32_32x32x16_bf16 v[128:143], v[216:219], v[72:75], v[128:143]
    v_mfma_f32_32x32x16_bf16 v[144:159], v[216:219], v[76:79], v[144:159]
    v_mfma_f32_32x32x16_bf16 v[160:175], v[220:223], v[72:75], v[160:175]
    v_mfma_f32_32x32x16_bf16 v[176:191], v[220:223], v[76:79], v[176:191]
    s_waitcnt vmcnt(21)
    s_waitcnt lgkmcnt(4)
    v_mfma_f32_32x32x16_bf16 v[128:143], v[224:227], v[80:83], v[128:143]
    v_mfma_f32_32x32x16_bf16 v[144:159], v[224:227], v[84:87], v[144:159]
    v_mfma_f32_32x32x16_bf16 v[160:175], v[228:231], v[80:83], v[160:175]
    v_mfma_f32_32x32x16_bf16 v[176:191], v[228:231], v[84:87], v[176:191]
    s_cmp_ge_u32 s22, 2
    s_cbranch_scc1 L_M_skip21
    s_waitcnt vmcnt(19)
    s_waitcnt lgkmcnt(0)
    v_mfma_f32_32x32x16_bf16 v[128:143], v[232:235], v[88:91], v[128:143]
    v_mfma_f32_32x32x16_bf16 v[144:159], v[232:235], v[92:95], v[144:159]
    v_mfma_f32_32x32x16_bf16 v[160:175], v[236:239], v[88:91], v[160:175]
    v_mfma_f32_32x32x16_bf16 v[176:191], v[236:239], v[92:95], v[176:191]
L_M_skip21:
    s_setprio 3
    s_cmp_eq_u32 s75, 1
    s_cbranch_scc1 L_M_s_np
    buffer_load_dword v11, v13, s[24:27], s65 offen sc1
L_M_s_np:
    v_add_u32 v252, s57, v2
    v_add_u32_e64 v253, s61, v2
    s_nop 7
    s_cmp_eq_u32 s22, 0
    s_cbranch_scc1 L_own0
    ds_write_b128 v252, v[128:131] offset:0
    ds_write_b128 v252, v[132:135] offset:1024
    ds_write_b128 v252, v[144:147] offset:2048
    ds_write_b128 v253, v[148:151] offset:16384
    s_branch L_nxt0
L_own0:
    s_nop 3
    v_pk_mov_b32 v[16:17], v[128:129], v[128:129] op_sel:[0,1]
    v_pk_mov_b32 v[18:19], v[130:131], v[130:131] op_sel:[0,1]
    v_pk_mov_b32 v[20:21], v[132:133], v[132:133] op_sel:[0,1]
    v_pk_mov_b32 v[22:23], v[134:135], v[134:135] op_sel:[0,1]
    v_pk_mov_b32 v[24:25], v[144:145], v[144:145] op_sel:[0,1]
    v_pk_mov_b32 v[26:27], v[146:147], v[146:147] op_sel:[0,1]
    v_pk_mov_b32 v[28:29], v[148:149], v[148:149] op_sel:[0,1]
    v_pk_mov_b32 v[30:31], v[150:151], v[150:151] op_sel:[0,1]
L_nxt0:
    s_cmp_eq_u32 s22, 1
    s_cbranch_scc1 L_own1
    ds_write_b128 v252, v[136:139] offset:12288
    ds_write_b128 v252, v[140:143] offset:13312
    ds_write_b128 v252, v[152:155] offset:14336
    ds_write_b128 v253, v[156:159] offset:17408
    s_branch L_nxt1
L_own1:
    s_nop 0
    v_pk_mov_b32 v[16:17], v[136:137], v[136:137] op_sel:[0,1]
    v_pk_mov_b32 v[18:19], v[138:139], v[138:139] op_sel:[0,1]
    v_pk_mov_b32 v[20:21], v[140:141], v[140:141] op_sel:[0,1]
    v_pk_mov_b32 v[22:23], v[142:143], v[142:143] op_sel:[0,1]
    v_pk_mov_b32 v[24:25], v[152:153], v[152:153] op_sel:[0,1]
    v_pk_mov_b32 v[26:27], v[154:155], v[154:155] op_sel:[0,1]
    v_pk_mov_b32 v[28:29], v[156:157], v[156:157] op_sel:[0,1]
    v_pk_mov_b32 v[30:31], v[158:159], v[158:159] op_sel:[0,1]
L_nxt1:
    s_cmp_eq_u32 s22, 2
    s_cbranch_scc1 L_own2
    ds_write_b128 v252, v[160:163] offset:24576
    ds_write_b128 v252, v[164:167] offset:25600
    ds_write_b128 v252, v[176:179] offset:26624
    ds_write_b128 v253, v[180:183] offset:18432
    s_branch L_nxt2
L_own2:
    s_nop 0
    v_pk_mov_b32 v[16:17], v[160:161], v[160:161] op_sel:[0,1]
    v_pk_mov_b32 v[18:19], v[162:163], v[162:163] op_sel:[0,1]
    v_pk_mov_b32 v[20:21], v[164:165], v[164:165] op_sel:[0,1]
    v_pk_mov_b32 v[22:23], v[166:167], v[166:167] op_sel:[0,1]
    v_pk_mov_b32 v[24:25], v[176:177], v[176:177] op_sel:[0,1]
    v_pk_mov_b32 v[26:27], v[178:179], v[178:179] op_sel:[0,1]
    v_pk_mov_b32 v[28:29], v[180:181], v[180:181] op_sel:[0,1]
    v_pk_mov_b32 v[30:31], v[182:183], v[182:183] op_sel:[0,1]
L_nxt2:
    s_cmp_eq_u32 s22, 3
    s_cbranch_scc1 L_own3
    ds_write_b128 v252, v[168:171] offset:36864
    ds_write_b128 v252, v[172:175] offset:37888
    ds_write_b128 v252, v[184:187] offset:38912
    ds_write_b128 v253, v[188:191] offset:19456
    s_branch L_nxt3
L_own3:
    s_nop 0
    v_pk_mov_b32 v[16:17], v[168:169], v[168:169] op_sel:[0,1]
    v_pk_mov_b32 v[18:19], v[170:171], v[170:171] op_sel:[0,1]
    v_pk_mov_b32 v[20:21], v[172:173], v[172:173] op_sel:[0,1]
    v_pk_mov_b32 v[22:23], v[174:175], v[174:175] op_sel:[0,1]
    v_pk_mov_b32 v[24:25], v[184:185], v[184:185] op_sel:[0,1]
    v_pk_mov_b32 v[26:27], v[186:187], v[186:187] op_sel:[0,1]
    v_pk_mov_b32 v[28:29], v[188:189], v[188:189] op_sel:[0,1]
    v_pk_mov_b32 v[30:31], v[190:191], v[190:191] op_sel:[0,1]
L_nxt3:
    s_lshl_b32 s71, s22, 5
    v_add_u32 v63, s71, v253
    s_waitcnt vmcnt(1)
    v_lshlrev_b32 v32, 16, v240
    v_and_b32 v33, s64, v240
    v_lshlrev_b32 v34, 16, v241
    v_and_b32 v35, s64, v241
    v_lshlrev_b32 v36, 16, v242
    v_and_b32 v37, s64, v242
    v_lshlrev_b32 v38, 16, v243
    v_and_b32 v39, s64, v243
    v_lshlrev_b32 v40, 16, v244
    v_and_b32 v41, s64, v244
    v_lshlrev_b32 v42, 16, v245
    v_and_b32 v43, s64, v245
    v_lshlrev_b32 v44, 16, v246
    v_and_b32 v45, s64, v246
    v_lshlrev_b32 v46, 16, v247
    v_and_b32 v47, s64, v247
    v_lshlrev_b32 v124, 16, v12
    v_lshlrev_b32 v126, 16, v3
    v_lshrrev_b32 v56, 4, v5
    v_mul_u32_u24 v56, 4128, v56
    v_bfe_u32 v57, v5, 3, 1
    v_mul_u32_u24 v57, 1040, v57
    v_add_u32 v56, v56, v57
    v_and_b32 v57, 7, v5
    v_lshl_add_u32 v56, v57, 7, v56
    v_lshl_add_u32 v56, v4, 3, v56
    v_add_u32_e64 v56, s71, v56
    s_add_u32 s71, s22, 1
    s_and_b32 s71, s71, 3
    s_mul_i32 s72, s71, 3072
    s_mul_i32 s73, s22, 12288
    s_add_u32 s72, s72, s73
    v_add_u32_e64 v120, s72, v2
    s_lshl_b32 s71, s71, 12
    s_lshl_b32 s72, s22, 10
    s_add_u32 s71, s71, s72
    s_add_u32 s71, s71, 65536
    v_add_u32_e64 v58, s71, v2
    s_add_u32 s71, s22, 2
    s_and_b32 s71, s71, 3
    s_mul_i32 s72, s71, 3072
    s_mul_i32 s73, s22, 12288
    s_add_u32 s72, s72, s73
    v_add_u32_e64 v121, s72, v2
    s_lshl_b32 s71, s71, 12
    s_lshl_b32 s72, s22, 10
    s_add_u32 s71, s71, s72
    s_add_u32 s71, s71, 65536
    v_add_u32_e64 v59, s71, v2
    s_add_u32 s71, s22, 3
    s_and_b32 s71, s71, 3
    s_mul_i32 s72, s71, 3072
    s_mul_i32 s73, s22, 12288
    s_add_u32 s72, s72, s73
    v_add_u32_e64 v122, s72, v2
    s_lshl_b32 s71, s71, 12
    s_lshl_b32 s72, s22, 10
    s_add_u32 s71, s71, s72
    s_add_u32 s71, s71, 65536
    v_add_u32_e64 v60, s71, v2
    v_pk_mul_f32 v[96:97], v[96:97], v[96:97]
    v_pk_mul_f32 v[98:99], v[98:99], v[98:99]
    v_pk_mul_f32 v[100:101], v[100:101], v[100:101]
    v_pk_mul_f32 v[102:103], v[102:103], v[102:103]
    s_mov_b32 s72, 0xbfb8aa3b
    s_mov_b32 s73, 0xbfb8aa3b
    v_and_b32_e64 v72, 1, v1
    v_lshl_add_u32 v72, v4, 2, v72
    v_mul_u32_u24 v72, 144, v72
    v_lshrrev_b32_e64 v73, 1, v5
    v_lshl_add_u32 v72, v73, 2, v72
    v_add_u32 v72, s57, v72
    v_lshrrev_b32 v75, 3, v1
    v_and_b32 v74, 7, v1
    v_lshlrev_b32 v74, 4, v74
    v_mul_u32_u24 v73, 144, v75
    v_add_u32 v73, v73, v74
    v_add_u32 v73, s57, v73
    v_lshl_add_u32 v74, v75, 10, v74
    s_waitcnt lgkmcnt(0)
    s_barrier
    ds_read_b128 v[160:163], v120 offset:0
    ds_read_b128 v[164:167], v120 offset:1024
    ds_read_b128 v[168:171], v120 offset:2048
    ds_read_b128 v[172:175], v58
    ds_read_b128 v[176:179], v121 offset:0
    ds_read_b128 v[180:183], v121 offset:1024
    ds_read_b128 v[184:187], v121 offset:2048
    ds_read_b128 v[188:191], v59
    ds_read_b128 v[192:195], v122 offset:0
    ds_read_b128 v[196:199], v122 offset:1024
    ds_read_b128 v[200:203], v122 offset:2048
    ds_read_b128 v[204:207], v60
    s_waitcnt lgkmcnt(8)
    s_nop 0
    v_pk_add_f32 v[16:17], v[16:17], v[160:161]
    v_pk_add_f32 v[18:19], v[18:19], v[162:163]
    v_pk_add_f32 v[20:21], v[20:21], v[164:165]
    v_pk_add_f32 v[22:23], v[22:23], v[166:167]
    v_pk_add_f32 v[24:25], v[24:25], v[168:169]
    v_pk_add_f32 v[26:27], v[26:27], v[170:171]
    v_pk_add_f32 v[28:29], v[28:29], v[172:173]
    v_pk_add_f32 v[30:31], v[30:31], v[174:175]
    s_waitcnt lgkmcnt(4)
    s_nop 0
    v_pk_add_f32 v[16:17], v[16:17], v[176:177]
    v_pk_add_f32 v[18:19], v[18:19], v[178:179]
    v_pk_add_f32 v[20:21], v[20:21], v[180:181]
    v_pk_add_f32 v[22:23], v[22:23], v[182:183]
    v_pk_add_f32 v[24:25], v[24:25], v[184:185]
    v_pk_add_f32 v[26:27], v[26:27], v[186:187]
    v_pk_add_f32 v[28:29], v[28:29], v[188:189]
    v_pk_add_f32 v[30:31], v[30:31], v[190:191]
    s_waitcnt lgkmcnt(0)
    s_nop 0
    v_pk_add_f32 v[16:17], v[16:17], v[192:193]
    v_pk_add_f32 v[18:19], v[18:19], v[194:195]
    v_pk_add_f32 v[20:21], v[20:21], v[196:197]
    v_pk_add_f32 v[22:23], v[22:23], v[198:199]
    v_pk_add_f32 v[24:25], v[24:25], v[200:201]
    v_pk_add_f32 v[26:27], v[26:27], v[202:203]
    v_pk_add_f32 v[28:29], v[28:29], v[204:205]
    v_pk_add_f32 v[30:31], v[30:31], v[206:207]
    s_cmp_eq_u32 s75, 1
    s_cbranch_scc1 L_M_s_have
    s_mov_b32 s70, 262144
    s_waitcnt vmcnt(0)
L_M_p3:
    v_cmp_ne_u32 vcc, v11, v14
    s_cbranch_vccz L_M_p3_ok
    s_sub_u32 s70, s70, 1
    s_cbranch_scc1 L_M_p3_ok
    s_sleep 2
    buffer_load_dword v11, v13, s[24:27], s65 offen sc1
    s_waitcnt vmcnt(0)
    s_branch L_M_p3
L_M_p3_ok:
    buffer_load_dwordx4 v[248:251], v7, s[24:27], s67 offen sc1
    buffer_load_dwordx4 v[104:107], v7, s[24:27], s68 offen sc1
L_M_s_have:
    v_pk_fma_f32 v[16:17], v[16:17], v[96:97], v[124:125] op_sel_hi:[1,1,0]
    v_pk_fma_f32 v[18:19], v[18:19], v[98:99], v[124:125] op_sel_hi:[1,1,0]
    v_pk_fma_f32 v[20:21], v[20:21], v[100:101], v[124:125] op_sel_hi:[1,1,0]
    v_pk_fma_f32 v[22:23], v[22:23], v[102:103], v[124:125] op_sel_hi:[1,1,0]
    v_pk_fma_f32 v[24:25], v[24:25], v[96:97], v[126:127] op_sel_hi:[1,1,0]
    v_pk_fma_f32 v[26:27], v[26:27], v[98:99], v[126:127] op_sel_hi:[1,1,0]
    v_pk_fma_f32 v[28:29], v[28:29], v[100:101], v[126:127] op_sel_hi:[1,1,0]
    v_pk_fma_f32 v[30:31], v[30:31], v[102:103], v[126:127] op_sel_hi:[1,1,0]
    v_pk_mul_f32 v[128:129], v[16:17], s[72:73]
    v_pk_mul_f32 v[130:131], v[18:19], s[72:73]
    v_pk_mul_f32 v[132:133], v[20:21], s[72:73]
    v_pk_mul_f32 v[134:135], v[22:23], s[72:73]
    v_pk_mul_f32 v[136:137], v[24:25], s[72:73]
    v_pk_mul_f32 v[138:139], v[26:27], s[72:73]
    v_pk_mul_f32 v[140:141], v[28:29], s[72:73]
    v_pk_mul_f32 v[142:143], v[30:31], s[72:73]
    v_exp_f32 v128, v128
    v_exp_f32 v129, v129
    v_exp_f32 v130, v130
    v_exp_f32 v131, v131
    v_exp_f32 v132, v132
    v_exp_f32 v133, v133
    v_exp_f32 v134, v134
    v_exp_f32 v135, v135
    v_exp_f32 v136, v136
    v_exp_f32 v137, v137
    v_exp_f32 v138, v138
    v_exp_f32 v139, v139
    v_exp_f32 v140, v140
    v_exp_f32 v141, v141
    v_exp_f32 v142, v142
    v_exp_f32 v143, v143
    v_pk_add_f32 v[128:129], v[128:129], 1.0 op_sel_hi:[1,0]
    v_pk_add_f32 v[130:131], v[130:131], 1.0 op_sel_hi:[1,0]
    v_pk_add_f32 v[132:133], v[132:133], 1.0 op_sel_hi:[1,0]
    v_pk_add_f32 v[134:135], v[134:135], 1.0 op_sel_hi:[1,0]
    v_pk_add_f32 v[136:137], v[136:137], 1.0 op_sel_hi:[1,0]
    v_pk_add_f32 v[138:139], v[138:139], 1.0 op_sel_hi:[1,0]
    v_pk_add_f32 v[140:141], v[140:141], 1.0 op_sel_hi:[1,0]
    v_pk_add_f32 v[142:143], v[142:143], 1.0 op_sel_hi:[1,0]
    s_waitcnt vmcnt(0)
    ds_write_b128 v63, v[248:251]
    ds_write_b128 v63, v[104:107] offset:1040
    v_rcp_f32 v128, v128
    v_rcp_f32 v129, v129
    v_rcp_f32 v130, v130
    v_rcp_f32 v131, v131
    v_rcp_f32 v132, v132
    v_rcp_f32 v133, v133
    v_rcp_f32 v134, v134
    v_rcp_f32_e64 v135, v135
    s_waitcnt lgkmcnt(0)
    s_barrier
    ds_read_b64 v[112:113], v56 offset:49152
    ds_read_b64 v[114:115], v56 offset:49168
    ds_read_b64 v[116:117], v56 offset:57408
    ds_read_b64 v[118:119], v56 offset:57424
    v_rcp_f32 v136, v136
    v_rcp_f32 v137, v137
    v_rcp_f32 v138, v138
    v_rcp_f32 v139, v139
    v_rcp_f32 v140, v140
    v_rcp_f32 v141, v141
    v_rcp_f32 v142, v142
    v_rcp_f32 v143, v143
    v_pk_mul_f32 v[128:129], v[128:129], v[16:17]
    v_pk_mul_f32 v[130:131], v[130:131], v[18:19]
    v_pk_mul_f32 v[132:133], v[132:133], v[20:21]
    v_pk_mul_f32 v[134:135], v[134:135], v[22:23]
    v_pk_mul_f32 v[136:137], v[136:137], v[24:25]
    v_pk_mul_f32 v[138:139], v[138:139], v[26:27]
    v_pk_mul_f32 v[140:141], v[140:141], v[28:29]
    v_pk_mul_f32 v[142:143], v[142:143], v[30:31]
    s_waitcnt lgkmcnt(0)
    v_lshlrev_b32 v144, 16, v112
    v_and_b32 v145, s64, v112
    v_lshlrev_b32 v146, 16, v113
    v_and_b32 v147, s64, v113
    v_lshlrev_b32 v148, 16, v114
    v_and_b32 v149, s64, v114
    v_lshlrev_b32 v150, 16, v115
    v_and_b32 v151, s64, v115
    v_lshlrev_b32 v152, 16, v116
    v_and_b32 v153, s64, v116
    v_lshlrev_b32 v154, 16, v117
    v_and_b32 v155, s64, v117
    v_lshlrev_b32 v156, 16, v118
    v_and_b32 v157, s64, v118
    v_lshlrev_b32 v158, 16, v119
    v_and_b32_e64 v159, s64, v119
    v_pk_mul_f32 v[128:129], v[128:129], v[144:145]
    v_pk_mul_f32 v[130:131], v[130:131], v[146:147]
    v_pk_mul_f32 v[132:133], v[132:133], v[148:149]
    v_pk_mul_f32 v[134:135], v[134:135], v[150:151]
    v_pk_mul_f32 v[136:137], v[136:137], v[152:153]
    v_pk_mul_f32 v[138:139], v[138:139], v[154:155]
    v_pk_mul_f32 v[140:141], v[140:141], v[156:157]
    v_pk_mul_f32 v[142:143], v[142:143], v[158:159]
    s_mov_b32 vcc_lo, 0x55555555
    s_mov_b32 vcc_hi, 0x55555555
    v_cndmask_b32_dpp v144, v129, v128, vcc quad_perm:[1,0,3,2] row_mask:0xf bank_mask:0xf
    v_cndmask_b32_dpp v146, v131, v130, vcc quad_perm:[1,0,3,2] row_mask:0xf bank_mask:0xf
    v_cndmask_b32_dpp v148, v133, v132, vcc quad_perm:[1,0,3,2] row_mask:0xf bank_mask:0xf
    v_cndmask_b32_dpp v150, v135, v134, vcc quad_perm:[1,0,3,2] row_mask:0xf bank_mask:0xf
    v_cndmask_b32_dpp v152, v137, v136, vcc quad_perm:[1,0,3,2] row_mask:0xf bank_mask:0xf
    v_cndmask_b32_dpp v154, v139, v138, vcc quad_perm:[1,0,3,2] row_mask:0xf bank_mask:0xf
    v_cndmask_b32_dpp v156, v141, v140, vcc quad_perm:[1,0,3,2] row_mask:0xf bank_mask:0xf
    v_cndmask_b32_dpp v158, v143, v142, vcc quad_perm:[1,0,3,2] row_mask:0xf bank_mask:0xf
    s_not_b64 vcc, vcc
    s_nop 0
    v_cndmask_b32_dpp v145, v128, v129, vcc quad_perm:[1,0,3,2] row_mask:0xf bank_mask:0xf
    v_cndmask_b32_dpp v147, v130, v131, vcc quad_perm:[1,0,3,2] row_mask:0xf bank_mask:0xf
    v_cndmask_b32_dpp v149, v132, v133, vcc quad_perm:[1,0,3,2] row_mask:0xf bank_mask:0xf
    v_cndmask_b32_dpp v151, v134, v135, vcc quad_perm:[1,0,3,2] row_mask:0xf bank_mask:0xf
    v_cndmask_b32_dpp v153, v136, v137, vcc quad_perm:[1,0,3,2] row_mask:0xf bank_mask:0xf
    v_cndmask_b32_dpp v155, v138, v139, vcc quad_perm:[1,0,3,2] row_mask:0xf bank_mask:0xf
    v_cndmask_b32_dpp v157, v140, v141, vcc quad_perm:[1,0,3,2] row_mask:0xf bank_mask:0xf
    v_cndmask_b32_dpp v159, v142, v143, vcc quad_perm:[1,0,3,2] row_mask:0xf bank_mask:0xf
    v_pk_add_f32 v[144:145], v[144:145], v[32:33]
    v_cvt_pk_bf16_f32 v64, v144, v145
    ds_write_b32 v72, v64 offset:0
    v_pk_add_f32 v[146:147], v[146:147], v[34:35]
    v_cvt_pk_bf16_f32 v65, v146, v147
    ds_write_b32 v72, v65 offset:288
    v_pk_add_f32 v[148:149], v[148:149], v[36:37]
    v_cvt_pk_bf16_f32 v66, v148, v149
    ds_write_b32 v72, v66 offset:1152
    v_pk_add_f32 v[150:151], v[150:151], v[38:39]
    v_cvt_pk_bf16_f32 v67, v150, v151
    ds_write_b32 v72, v67 offset:1440
    v_pk_add_f32 v[152:153], v[152:153], v[40:41]
    v_cvt_pk_bf16_f32 v68, v152, v153
    ds_write_b32 v72, v68 offset:64
    v_pk_add_f32 v[154:155], v[154:155], v[42:43]
    v_cvt_pk_bf16_f32 v69, v154, v155
    ds_write_b32 v72, v69 offset:352
    v_pk_add_f32 v[156:157], v[156:157], v[44:45]
    v_cvt_pk_bf16_f32 v70, v156, v157
    ds_write_b32 v72, v70 offset:1216
    v_pk_add_f32 v[158:159], v[158:159], v[46:47]
    v_cvt_pk_bf16_f32 v71, v158, v159
    ds_write_b32 v72, v71 offset:1504
    s_waitcnt lgkmcnt(0)
    ds_read_b128 v[76:79], v73
    ds_read_b128 v[80:83], v73 offset:1152
    s_waitcnt lgkmcnt(1)
    buffer_store_dwordx4 v[76:79], v74, s[44:47], s54 offen sc1
    s_waitcnt lgkmcnt(0)
    buffer_store_dwordx4 v[80:83], v74, s[44:47], s55 offen sc1
L_M_exit:
    s_endpgm
L_Mend:

.section .rodata,"a"
.p2align 6
.amdhsa_kernel recurrent_scan__ssm_conv_s4__dense_activation_squared_relu__prompt_kernel
  .amdhsa_next_free_vgpr 256
  .amdhsa_next_free_sgpr 102
  .amdhsa_accum_offset 256
  .amdhsa_group_segment_fixed_size 0
  .amdhsa_kernarg_size 136
  .amdhsa_ieee_mode 0
  .amdhsa_user_sgpr_count 2
  .amdhsa_user_sgpr_kernarg_segment_ptr 1
  .amdhsa_system_sgpr_workgroup_id_x 1
.end_amdhsa_kernel
.text
```
